```python
import torch

def _softmax(x, axis=-1):
    return torch.softmax(x, dim=axis)
def _gelu(x):
    return torch.nn.functional.gelu(x, approximate="tanh")
def _silu(x):
    return torch.nn.functional.silu(x)
def _sigmoid(x):
    return torch.sigmoid(x)
def _layernorm(x, axis=-1, eps=1e-5):
    m = x.mean(dim=axis, keepdim=True)
    v = x.var(dim=axis, keepdim=True, unbiased=False)
    return (x - m) / torch.sqrt(v + eps)
def _scatter_add(tgt, idx, src, axis=0):
    return tgt.clone().index_add_(axis, idx, src)
def _segment_sum(src, seg, n):
    out = torch.zeros((n,) + src.shape[1:], dtype=src.dtype)
    return out.index_add_(0, seg, src)
def _pad(x, pw):
    flat = tuple(v for pair in reversed(pw) for v in pair)
    return torch.nn.functional.pad(x, flat)

kernel_name = 'standalone__mha_softmax__near_ridge'

def setup_inputs():

    _w = (lambda a: (lambda t: t.to(torch.bfloat16) if t.is_floating_point() else t)(torch.as_tensor(a)))
    B, H, Sq, Sk, D = 8, 16, 512, 1024, 256
    return {
        "q": _w((lambda *s: torch.randn(*s, dtype=torch.bfloat16) * 0.8)(B, H, Sq, D)),
        "k": _w((lambda *s: torch.randn(*s, dtype=torch.bfloat16) * 0.8)(B, H, Sk, D)),
        "v": _w((lambda *s: torch.randn(*s, dtype=torch.bfloat16) * 0.05)(B, H, Sk, D)),
    }

def reference(q, k, v):
    scale = q.shape[-1] ** -0.5
    scores = torch.einsum("bhqd,bhkd->bhqk", q, k) * scale
    p = _softmax(scores, axis=-1)
    return torch.einsum("bhqk,bhkd->bhqd", p, v)
```

```asm
; @launch grid=(256,1,1) block=(256,1,1) lds=163840
.amdgcn_target "amdgcn-amd-amdhsa--gfx950"
.text
.globl standalone__mha_softmax__near_ridge_kernel
.p2align 8
.type standalone__mha_softmax__near_ridge_kernel,@function
standalone__mha_softmax__near_ridge_kernel:
    s_cmp_ge_u32 s2, 256
    s_cbranch_scc1 L_end
    s_load_dwordx4 s[4:7], s[0:1], 0
    s_load_dwordx4 s[8:11], s[0:1], 16
    v_lshrrev_b32 v64, 6, v0
    v_and_b32 v65, 63, v0
    v_readfirstlane_b32 s41, v64
    v_and_b32 v66, 31, v65
    v_lshrrev_b32 v67, 5, v65
    v_and_b32 v68, 15, v65
    v_lshrrev_b32 v69, 4, v65
    s_lshl_b32 s29, s41, 12
    s_and_b32 s3, s2, 7
    s_lshr_b32 s42, s2, 3
    s_lshl_b32 s3, s3, 4
    s_lshr_b32 s43, s42, 1
    s_add_u32 s3, s3, s43
    s_and_b32 s42, s42, 1
    s_lshl_b32 s43, s3, 19
    s_lshl_b32 s44, s3, 18
    s_lshl_b32 s42, s42, 17
    s_add_u32 s44, s44, s42
    s_mov_b32 s28, 0x3db8aa3b
    s_mov_b32 s33, 0
    s_mov_b32 s36, 0
    s_mov_b32 s50, 0
    s_mov_b32 s51, 4096
    s_mov_b32 s52, 8192
    s_mov_b32 s53, 12288
    s_mov_b32 s54, 16384
    s_mov_b32 s55, 20480
    s_mov_b32 s56, 24576
    s_mov_b32 s57, 28672
    v_and_b32 v70, 1, v64
    v_lshl_add_u32 v70, v70, 3, v67
    v_xor_b32 v70, v70, v66
    v_lshlrev_b32 v70, 4, v70
    v_lshl_add_u32 v70, v67, 9, v70
    v_lshl_add_u32 v12, v64, 12, v70
    v_xor_b32 v70, v67, v66
    v_lshlrev_b32 v70, 4, v70
    v_lshl_add_u32 v72, v67, 9, v70
    v_xor_b32 v73, 128, v72
    v_lshlrev_b32 v70, 1, v67
    v_xor_b32 v70, v70, v66
    v_lshlrev_b32 v70, 4, v70
    v_lshl_add_u32 v70, v67, 9, v70
    v_lshl_add_u32 v13, v64, 12, v70
    s_waitcnt lgkmcnt(0)
    s_add_u32 s16, s6, s43
    s_addc_u32 s17, s7, 0
    s_and_b32 s17, s17, 0xffff
    s_mov_b32 s18, 524288
    s_mov_b32 s19, 0x00020000
    s_add_u32 s12, s4, s44
    s_addc_u32 s13, s5, 0
    s_and_b32 s13, s13, 0xffff
    s_mov_b32 s14, 131072
    s_mov_b32 s15, 0x00020000
    s_add_u32 s20, s8, s43
    s_addc_u32 s21, s9, 0
    s_and_b32 s21, s21, 0xffff
    s_mov_b32 s22, 524288
    s_mov_b32 s23, 0x00020000
    s_add_u32 s24, s10, s44
    s_addc_u32 s25, s11, 0
    s_and_b32 s25, s25, 0xffff
    s_mov_b32 s26, 131072
    s_mov_b32 s27, 0x00020000
    v_mov_b32 v26, v72
    v_mov_b32 v27, v73
    s_cmp_lg_u32 s42, 0
    s_cbranch_scc1 L_pro2
    s_mov_b32 s30, 0
    s_add_u32 m0, s29, 0
    s_nop 0
    buffer_load_dwordx4 v12, s[16:19], s30 offen offset:0 lds
    v_xor_b32 v14, 32, v12
    buffer_load_dwordx4 v14, s[16:19], s30 offen offset:1024 lds
    v_xor_b32 v14, 64, v12
    buffer_load_dwordx4 v14, s[16:19], s30 offen offset:2048 lds
    v_xor_b32 v14, 96, v12
    buffer_load_dwordx4 v14, s[16:19], s30 offen offset:3072 lds
    s_lshl_b32 s45, s41, 15
    s_add_u32 m0, s29, 65536
    s_nop 0
    buffer_load_dwordx4 v26, s[12:15], s45 offen offset:0 nt lds
    v_xor_b32 v14, 32, v26
    buffer_load_dwordx4 v14, s[12:15], s45 offen offset:1024 nt lds
    v_xor_b32 v14, 64, v26
    buffer_load_dwordx4 v14, s[12:15], s45 offen offset:2048 nt lds
    v_xor_b32 v14, 96, v26
    buffer_load_dwordx4 v14, s[12:15], s45 offen offset:3072 nt lds
    s_lshl_b32 s45, s41, 15
    s_add_u32 s45, s45, 4096
    s_add_u32 m0, s29, 32768
    s_nop 0
    buffer_load_dwordx4 v27, s[12:15], s45 offen offset:0 nt lds
    v_xor_b32 v14, 32, v27
    buffer_load_dwordx4 v14, s[12:15], s45 offen offset:1024 nt lds
    v_xor_b32 v14, 64, v27
    buffer_load_dwordx4 v14, s[12:15], s45 offen offset:2048 nt lds
    v_xor_b32 v14, 96, v27
    buffer_load_dwordx4 v14, s[12:15], s45 offen offset:3072 nt lds
    s_lshl_b32 s45, s41, 15
    s_add_u32 s45, s45, 8192
    s_add_u32 m0, s29, 81920
    s_nop 0
    buffer_load_dwordx4 v26, s[12:15], s45 offen offset:0 nt lds
    v_xor_b32 v14, 32, v26
    buffer_load_dwordx4 v14, s[12:15], s45 offen offset:1024 nt lds
    v_xor_b32 v14, 64, v26
    buffer_load_dwordx4 v14, s[12:15], s45 offen offset:2048 nt lds
    v_xor_b32 v14, 96, v26
    buffer_load_dwordx4 v14, s[12:15], s45 offen offset:3072 nt lds
    s_lshl_b32 s45, s41, 15
    s_add_u32 s45, s45, 12288
    s_add_u32 m0, s29, 49152
    s_nop 0
    buffer_load_dwordx4 v27, s[12:15], s45 offen offset:0 nt lds
    v_xor_b32 v14, 32, v27
    buffer_load_dwordx4 v14, s[12:15], s45 offen offset:1024 nt lds
    v_xor_b32 v14, 64, v27
    buffer_load_dwordx4 v14, s[12:15], s45 offen offset:2048 nt lds
    v_xor_b32 v14, 96, v27
    buffer_load_dwordx4 v14, s[12:15], s45 offen offset:3072 nt lds
    s_lshl_b32 s45, s41, 15
    s_add_u32 s45, s45, 16384
    s_add_u32 m0, s29, 98304
    s_nop 0
    buffer_load_dwordx4 v26, s[12:15], s45 offen offset:0 nt lds
    v_xor_b32 v14, 32, v26
    buffer_load_dwordx4 v14, s[12:15], s45 offen offset:1024 nt lds
    v_xor_b32 v14, 64, v26
    buffer_load_dwordx4 v14, s[12:15], s45 offen offset:2048 nt lds
    v_xor_b32 v14, 96, v26
    buffer_load_dwordx4 v14, s[12:15], s45 offen offset:3072 nt lds
    s_lshl_b32 s45, s41, 15
    s_add_u32 s45, s45, 20480
    s_add_u32 m0, s29, 114688
    s_nop 0
    buffer_load_dwordx4 v27, s[12:15], s45 offen offset:0 nt lds
    v_xor_b32 v14, 32, v27
    buffer_load_dwordx4 v14, s[12:15], s45 offen offset:1024 nt lds
    v_xor_b32 v14, 64, v27
    buffer_load_dwordx4 v14, s[12:15], s45 offen offset:2048 nt lds
    v_xor_b32 v14, 96, v27
    buffer_load_dwordx4 v14, s[12:15], s45 offen offset:3072 nt lds
    s_lshl_b32 s45, s41, 15
    s_add_u32 s45, s45, 24576
    s_add_u32 m0, s29, 131072
    s_nop 0
    buffer_load_dwordx4 v26, s[12:15], s45 offen offset:0 nt lds
    v_xor_b32 v14, 32, v26
    buffer_load_dwordx4 v14, s[12:15], s45 offen offset:1024 nt lds
    v_xor_b32 v14, 64, v26
    buffer_load_dwordx4 v14, s[12:15], s45 offen offset:2048 nt lds
    v_xor_b32 v14, 96, v26
    buffer_load_dwordx4 v14, s[12:15], s45 offen offset:3072 nt lds
    s_lshl_b32 s45, s41, 15
    s_add_u32 s45, s45, 28672
    s_add_u32 m0, s29, 147456
    s_nop 0
    buffer_load_dwordx4 v27, s[12:15], s45 offen offset:0 nt lds
    v_xor_b32 v14, 32, v27
    buffer_load_dwordx4 v14, s[12:15], s45 offen offset:1024 nt lds
    v_xor_b32 v14, 64, v27
    buffer_load_dwordx4 v14, s[12:15], s45 offen offset:2048 nt lds
    v_xor_b32 v14, 96, v27
    buffer_load_dwordx4 v14, s[12:15], s45 offen offset:3072 nt lds
    s_mov_b32 s30, 16384
    s_add_u32 m0, s29, 16384
    s_nop 0
    buffer_load_dwordx4 v12, s[16:19], s30 offen offset:0 lds
    v_xor_b32 v14, 32, v12
    buffer_load_dwordx4 v14, s[16:19], s30 offen offset:1024 lds
    v_xor_b32 v14, 64, v12
    buffer_load_dwordx4 v14, s[16:19], s30 offen offset:2048 lds
    v_xor_b32 v14, 96, v12
    buffer_load_dwordx4 v14, s[16:19], s30 offen offset:3072 lds
    v_xor_b32 v70, v69, v68
    v_lshlrev_b32 v70, 4, v70
    v_lshl_add_u32 v0, v68, 9, v70
    v_xor_b32 v1, 64, v0
    v_xor_b32 v2, 128, v0
    v_xor_b32 v3, 192, v0
    v_lshrrev_b32 v70, 2, v68
    v_and_b32 v71, 3, v68
    v_lshl_add_u32 v74, v69, 2, v70
    v_and_b32 v75, 7, v74
    v_lshlrev_b32 v74, 9, v74
    v_lshl_add_u32 v74, v75, 5, v74
    v_lshl_add_u32 v74, v71, 3, v74
    v_add_u32 v4, 65536, v74
    v_xor_b32 v5, 32, v4
    v_xor_b32 v6, 64, v4
    v_xor_b32 v7, 96, v4
    v_xor_b32 v8, 128, v4
    v_xor_b32 v9, 160, v4
    v_xor_b32 v10, 192, v4
    v_xor_b32 v11, 224, v4
    v_and_b32 v70, 7, v68
    v_xor_b32 v71, v69, v68
    v_lshlrev_b32 v71, 4, v71
    v_lshl_add_u32 v71, v70, 9, v71
    v_lshl_add_u32 v15, v64, 12, v71
    v_cmp_lt_u32 s[46:47], 7, v68
    v_mov_b32 v20, 0
    v_mov_b32 v21, 0
    v_mov_b32 v22, 0
    v_mov_b32 v23, 0
    s_nop 1
    v_mfma_f32_32x32x16_bf16 a[0:15], v[20:23], v[20:23], 0
    v_mfma_f32_32x32x16_bf16 a[16:31], v[20:23], v[20:23], 0
    v_mfma_f32_32x32x16_bf16 a[32:47], v[20:23], v[20:23], 0
    v_mfma_f32_32x32x16_bf16 a[48:63], v[20:23], v[20:23], 0
    v_mfma_f32_32x32x16_bf16 a[64:79], v[20:23], v[20:23], 0
    v_mfma_f32_32x32x16_bf16 a[80:95], v[20:23], v[20:23], 0
    v_mfma_f32_32x32x16_bf16 a[96:111], v[20:23], v[20:23], 0
    v_mfma_f32_32x32x16_bf16 a[112:127], v[20:23], v[20:23], 0
    v_mfma_f32_32x32x16_bf16 a[128:143], v[20:23], v[20:23], 0
    v_mfma_f32_32x32x16_bf16 a[144:159], v[20:23], v[20:23], 0
    v_mfma_f32_32x32x16_bf16 a[160:175], v[20:23], v[20:23], 0
    v_mfma_f32_32x32x16_bf16 a[176:191], v[20:23], v[20:23], 0
    v_mfma_f32_32x32x16_bf16 a[192:207], v[20:23], v[20:23], 0
    v_mfma_f32_32x32x16_bf16 a[208:223], v[20:23], v[20:23], 0
    v_mfma_f32_32x32x16_bf16 a[224:239], v[20:23], v[20:23], 0
    v_mfma_f32_32x32x16_bf16 a[240:255], v[20:23], v[20:23], 0
    s_waitcnt vmcnt(36)
    s_barrier
    ds_read_b128 v[32:35], v0 offset:0
    ds_read_b128 v[36:39], v1 offset:0
    ds_read_b128 v[40:43], v2 offset:0
    ds_read_b128 v[44:47], v3 offset:0
    ds_read_b128 v[48:51], v0 offset:256
    ds_read_b128 v[52:55], v1 offset:256
    ds_read_b128 v[56:59], v2 offset:256
    ds_read_b128 v[60:63], v3 offset:256
    ds_read_b128 v[96:99], v0 offset:8192
    ds_read_b128 v[100:103], v1 offset:8192
    ds_read_b128 v[104:107], v2 offset:8192
    ds_read_b128 v[108:111], v3 offset:8192
    ds_read_b128 v[112:115], v0 offset:8448
    ds_read_b128 v[116:119], v1 offset:8448
    ds_read_b128 v[120:123], v2 offset:8448
    ds_read_b128 v[124:127], v3 offset:8448
    v_mov_b32 v28, 65536
    v_mov_b32 v29, 32768
    v_cndmask_b32 v28, v28, v29, s[46:47]
    v_add_u32 v28, v28, v15
    v_xor_b32 v29, 64, v28
    v_xor_b32 v30, 128, v28
    v_xor_b32 v31, 192, v28
    s_waitcnt vmcnt(28)
    ds_read_b128 v[128:131], v28 offset:0
    ds_read_b128 v[132:135], v29 offset:0
    ds_read_b128 v[136:139], v30 offset:0
    ds_read_b128 v[140:143], v31 offset:0
    ds_read_b128 v[144:147], v28 offset:256
    ds_read_b128 v[148:151], v29 offset:256
    ds_read_b128 v[152:155], v30 offset:256
    ds_read_b128 v[156:159], v31 offset:256
    s_waitcnt lgkmcnt(0)
    v_mfma_f32_16x16x32_bf16 v[64:67], v[32:35], v[128:131], 0
    v_mfma_f32_16x16x32_bf16 v[64:67], v[36:39], v[132:135], v[64:67]
    v_mfma_f32_16x16x32_bf16 v[64:67], v[40:43], v[136:139], v[64:67]
    v_mfma_f32_16x16x32_bf16 v[64:67], v[44:47], v[140:143], v[64:67]
    v_mfma_f32_16x16x32_bf16 v[64:67], v[48:51], v[144:147], v[64:67]
    v_mfma_f32_16x16x32_bf16 v[64:67], v[52:55], v[148:151], v[64:67]
    v_mfma_f32_16x16x32_bf16 v[64:67], v[56:59], v[152:155], v[64:67]
    v_mfma_f32_16x16x32_bf16 v[64:67], v[60:63], v[156:159], v[64:67]
    v_mfma_f32_16x16x32_bf16 v[68:71], v[96:99], v[128:131], 0
    v_mfma_f32_16x16x32_bf16 v[68:71], v[100:103], v[132:135], v[68:71]
    v_mfma_f32_16x16x32_bf16 v[68:71], v[104:107], v[136:139], v[68:71]
    v_mfma_f32_16x16x32_bf16 v[68:71], v[108:111], v[140:143], v[68:71]
    v_mfma_f32_16x16x32_bf16 v[68:71], v[112:115], v[144:147], v[68:71]
    v_mfma_f32_16x16x32_bf16 v[68:71], v[116:119], v[148:151], v[68:71]
    v_mfma_f32_16x16x32_bf16 v[68:71], v[120:123], v[152:155], v[68:71]
    v_mfma_f32_16x16x32_bf16 v[68:71], v[124:127], v[156:159], v[68:71]
    s_nop 7
    v_max3_f32 v24, v64, v65, v66
    v_max_f32 v24, v24, v67
    v_max3_f32 v24, v24, v68, v69
    v_max3_f32 v24, v24, v70, v71
    v_mov_b32 v28, v24
    s_nop 1
    v_permlane16_swap_b32 v24, v28
    s_nop 1
    v_max_f32 v24, v24, v28
    v_mov_b32 v28, v24
    s_nop 1
    v_permlane32_swap_b32 v24, v28
    s_nop 1
    v_max_f32 v24, v24, v28
    v_mul_f32 v16, s28, v24
    v_sub_f32 v16, 0, v16
    v_fma_f32 v64, v64, s28, v16
    v_fma_f32 v65, v65, s28, v16
    v_exp_f32 v64, v64
    s_nop 0
    v_add_f32 v20, v20, v64
    v_fma_f32 v66, v66, s28, v16
    v_exp_f32 v65, v65
    s_nop 0
    v_cvt_pk_bf16_f32 v64, v64, v65
    v_add_f32 v20, v20, v65
    v_fma_f32 v67, v67, s28, v16
    v_exp_f32 v66, v66
    s_nop 0
    v_exp_f32 v67, v67
    s_nop 0
    v_add_f32 v20, v20, v66
    v_cvt_pk_bf16_f32 v65, v66, v67
    v_add_f32 v20, v20, v67
    v_mov_b32 v28, 81920
    v_mov_b32 v29, 49152
    v_cndmask_b32 v28, v28, v29, s[46:47]
    v_add_u32 v28, v28, v15
    v_xor_b32 v29, 64, v28
    v_xor_b32 v30, 128, v28
    v_xor_b32 v31, 192, v28
    s_waitcnt vmcnt(20)
    ds_read_b128 v[160:163], v28 offset:0
    ds_read_b128 v[164:167], v29 offset:0
    ds_read_b128 v[168:171], v30 offset:0
    ds_read_b128 v[172:175], v31 offset:0
    ds_read_b128 v[176:179], v28 offset:256
    ds_read_b128 v[180:183], v29 offset:256
    ds_read_b128 v[184:187], v30 offset:256
    ds_read_b128 v[188:191], v31 offset:256
    s_waitcnt lgkmcnt(0)
    s_mov_b32 s31, 0
    s_add_u32 m0, s29, 65536
    s_nop 0
    buffer_load_dwordx4 v13, s[20:23], s31 offen offset:0 lds
    v_xor_b32 v14, 64, v13
    buffer_load_dwordx4 v14, s[20:23], s31 offen offset:1024 lds
    v_xor_b32 v14, 128, v13
    buffer_load_dwordx4 v14, s[20:23], s31 offen offset:2048 lds
    v_xor_b32 v14, 192, v13
    buffer_load_dwordx4 v14, s[20:23], s31 offen offset:3072 lds
    v_mfma_f32_16x16x32_bf16 v[72:75], v[32:35], v[160:163], 0
    v_mfma_f32_16x16x32_bf16 v[72:75], v[36:39], v[164:167], v[72:75]
    v_mfma_f32_16x16x32_bf16 v[72:75], v[40:43], v[168:171], v[72:75]
    v_mfma_f32_16x16x32_bf16 v[72:75], v[44:47], v[172:175], v[72:75]
    v_mfma_f32_16x16x32_bf16 v[72:75], v[48:51], v[176:179], v[72:75]
    v_mfma_f32_16x16x32_bf16 v[72:75], v[52:55], v[180:183], v[72:75]
    v_mfma_f32_16x16x32_bf16 v[72:75], v[56:59], v[184:187], v[72:75]
    v_mfma_f32_16x16x32_bf16 v[72:75], v[60:63], v[188:191], v[72:75]
    v_mfma_f32_16x16x32_bf16 v[76:79], v[96:99], v[160:163], 0
    v_mfma_f32_16x16x32_bf16 v[76:79], v[100:103], v[164:167], v[76:79]
    v_mfma_f32_16x16x32_bf16 v[76:79], v[104:107], v[168:171], v[76:79]
    v_mfma_f32_16x16x32_bf16 v[76:79], v[108:111], v[172:175], v[76:79]
    v_mfma_f32_16x16x32_bf16 v[76:79], v[112:115], v[176:179], v[76:79]
    v_mfma_f32_16x16x32_bf16 v[76:79], v[116:119], v[180:183], v[76:79]
    v_mfma_f32_16x16x32_bf16 v[76:79], v[120:123], v[184:187], v[76:79]
    v_mfma_f32_16x16x32_bf16 v[76:79], v[124:127], v[188:191], v[76:79]
    s_nop 7
    v_max3_f32 v25, v72, v73, v74
    v_max_f32 v25, v25, v75
    v_max3_f32 v25, v25, v76, v77
    v_max3_f32 v25, v25, v78, v79
    v_mov_b32 v28, v25
    s_nop 1
    v_permlane16_swap_b32 v25, v28
    s_nop 1
    v_max_f32 v25, v25, v28
    v_mov_b32 v28, v25
    s_nop 1
    v_permlane32_swap_b32 v25, v28
    s_nop 1
    v_max_f32 v25, v25, v28
    v_mul_f32 v17, s28, v25
    v_sub_f32 v17, 0, v17
    v_fma_f32 v72, v72, s28, v17
    v_fma_f32 v73, v73, s28, v17
    v_exp_f32 v72, v72
    s_nop 0
    v_exp_f32 v73, v73
    s_nop 0
    v_add_f32 v21, v21, v72
    v_cvt_pk_bf16_f32 v72, v72, v73
    v_add_f32 v21, v21, v73
    v_fma_f32 v74, v74, s28, v17
    v_exp_f32 v74, v74
    s_nop 0
    v_fma_f32 v75, v75, s28, v17
    v_add_f32 v21, v21, v74
    v_exp_f32 v75, v75
    s_nop 0
    v_cvt_pk_bf16_f32 v73, v74, v75
    v_add_f32 v21, v21, v75
    v_mov_b32 v28, 98304
    v_mov_b32 v29, 114688
    v_cndmask_b32 v28, v28, v29, s[46:47]
    v_add_u32 v28, v28, v15
    v_xor_b32 v29, 64, v28
    v_xor_b32 v30, 128, v28
    v_xor_b32 v31, 192, v28
    s_waitcnt vmcnt(16)
    ds_read_b128 v[192:195], v28 offset:0
    ds_read_b128 v[196:199], v29 offset:0
    ds_read_b128 v[200:203], v30 offset:0
    ds_read_b128 v[204:207], v31 offset:0
    ds_read_b128 v[208:211], v28 offset:256
    ds_read_b128 v[212:215], v29 offset:256
    ds_read_b128 v[216:219], v30 offset:256
    ds_read_b128 v[220:223], v31 offset:256
    s_waitcnt lgkmcnt(0)
    s_mov_b32 s30, 32768
    s_add_u32 m0, s29, 32768
    s_nop 0
    buffer_load_dwordx4 v12, s[16:19], s30 offen offset:0 lds
    v_xor_b32 v14, 32, v12
    buffer_load_dwordx4 v14, s[16:19], s30 offen offset:1024 lds
    v_xor_b32 v14, 64, v12
    buffer_load_dwordx4 v14, s[16:19], s30 offen offset:2048 lds
    v_xor_b32 v14, 96, v12
    buffer_load_dwordx4 v14, s[16:19], s30 offen offset:3072 lds
    v_mfma_f32_16x16x32_bf16 v[80:83], v[32:35], v[192:195], 0
    v_mfma_f32_16x16x32_bf16 v[80:83], v[36:39], v[196:199], v[80:83]
    v_mfma_f32_16x16x32_bf16 v[80:83], v[40:43], v[200:203], v[80:83]
    v_mfma_f32_16x16x32_bf16 v[80:83], v[44:47], v[204:207], v[80:83]
    v_mfma_f32_16x16x32_bf16 v[80:83], v[48:51], v[208:211], v[80:83]
    v_mfma_f32_16x16x32_bf16 v[80:83], v[52:55], v[212:215], v[80:83]
    v_mfma_f32_16x16x32_bf16 v[80:83], v[56:59], v[216:219], v[80:83]
    v_mfma_f32_16x16x32_bf16 v[80:83], v[60:63], v[220:223], v[80:83]
    v_mfma_f32_16x16x32_bf16 v[84:87], v[96:99], v[192:195], 0
    v_mfma_f32_16x16x32_bf16 v[84:87], v[100:103], v[196:199], v[84:87]
    v_mfma_f32_16x16x32_bf16 v[84:87], v[104:107], v[200:203], v[84:87]
    v_mfma_f32_16x16x32_bf16 v[84:87], v[108:111], v[204:207], v[84:87]
    v_mfma_f32_16x16x32_bf16 v[84:87], v[112:115], v[208:211], v[84:87]
    v_mfma_f32_16x16x32_bf16 v[84:87], v[116:119], v[212:215], v[84:87]
    v_mfma_f32_16x16x32_bf16 v[84:87], v[120:123], v[216:219], v[84:87]
    v_mfma_f32_16x16x32_bf16 v[84:87], v[124:127], v[220:223], v[84:87]
    s_nop 7
    v_max3_f32 v26, v80, v81, v82
    v_max_f32 v26, v26, v83
    v_max3_f32 v26, v26, v84, v85
    v_max3_f32 v26, v26, v86, v87
    v_mov_b32 v28, v26
    s_nop 1
    v_permlane16_swap_b32 v26, v28
    s_nop 1
    v_max_f32 v26, v26, v28
    v_mov_b32 v28, v26
    s_nop 1
    v_permlane32_swap_b32 v26, v28
    s_nop 1
    v_max_f32 v26, v26, v28
    v_mul_f32 v18, s28, v26
    v_sub_f32 v18, 0, v18
    v_fma_f32 v80, v80, s28, v18
    v_fma_f32 v81, v81, s28, v18
    v_exp_f32 v80, v80
    s_nop 0
    v_exp_f32 v81, v81
    s_nop 0
    v_add_f32 v22, v22, v80
    v_cvt_pk_bf16_f32 v80, v80, v81
    v_add_f32 v22, v22, v81
    v_fma_f32 v82, v82, s28, v18
    v_exp_f32 v82, v82
    s_nop 0
    v_fma_f32 v83, v83, s28, v18
    v_add_f32 v22, v22, v82
    v_exp_f32 v83, v83
    s_nop 0
    v_cvt_pk_bf16_f32 v81, v82, v83
    v_add_f32 v22, v22, v83
    v_mov_b32 v28, 131072
    v_mov_b32 v29, 147456
    v_cndmask_b32 v28, v28, v29, s[46:47]
    v_add_u32 v28, v28, v15
    v_xor_b32 v29, 64, v28
    v_xor_b32 v30, 128, v28
    v_xor_b32 v31, 192, v28
    s_waitcnt vmcnt(12)
    ds_read_b128 v[224:227], v28 offset:0
    ds_read_b128 v[228:231], v29 offset:0
    ds_read_b128 v[232:235], v30 offset:0
    ds_read_b128 v[236:239], v31 offset:0
    ds_read_b128 v[240:243], v28 offset:256
    ds_read_b128 v[244:247], v29 offset:256
    ds_read_b128 v[248:251], v30 offset:256
    ds_read_b128 v[252:255], v31 offset:256
    s_waitcnt lgkmcnt(0)
    s_mov_b32 s31, 16384
    s_add_u32 m0, s29, 81920
    s_nop 0
    buffer_load_dwordx4 v13, s[20:23], s31 offen offset:0 lds
    v_xor_b32 v14, 64, v13
    buffer_load_dwordx4 v14, s[20:23], s31 offen offset:1024 lds
    v_xor_b32 v14, 128, v13
    buffer_load_dwordx4 v14, s[20:23], s31 offen offset:2048 lds
    v_xor_b32 v14, 192, v13
    buffer_load_dwordx4 v14, s[20:23], s31 offen offset:3072 lds
    s_mov_b32 s30, 49152
    s_add_u32 m0, s29, 49152
    s_nop 0
    buffer_load_dwordx4 v12, s[16:19], s30 offen offset:0 lds
    v_xor_b32 v14, 32, v12
    buffer_load_dwordx4 v14, s[16:19], s30 offen offset:1024 lds
    v_xor_b32 v14, 64, v12
    buffer_load_dwordx4 v14, s[16:19], s30 offen offset:2048 lds
    v_xor_b32 v14, 96, v12
    buffer_load_dwordx4 v14, s[16:19], s30 offen offset:3072 lds
    s_mov_b32 s31, 32768
    s_add_u32 m0, s29, 98304
    s_nop 0
    buffer_load_dwordx4 v13, s[20:23], s31 offen offset:0 lds
    v_xor_b32 v14, 64, v13
    buffer_load_dwordx4 v14, s[20:23], s31 offen offset:1024 lds
    v_xor_b32 v14, 128, v13
    buffer_load_dwordx4 v14, s[20:23], s31 offen offset:2048 lds
    v_xor_b32 v14, 192, v13
    buffer_load_dwordx4 v14, s[20:23], s31 offen offset:3072 lds
    v_mfma_f32_16x16x32_bf16 v[88:91], v[32:35], v[224:227], 0
    v_mfma_f32_16x16x32_bf16 v[88:91], v[36:39], v[228:231], v[88:91]
    v_mfma_f32_16x16x32_bf16 v[88:91], v[40:43], v[232:235], v[88:91]
    v_mfma_f32_16x16x32_bf16 v[88:91], v[44:47], v[236:239], v[88:91]
    v_mfma_f32_16x16x32_bf16 v[88:91], v[48:51], v[240:243], v[88:91]
    v_mfma_f32_16x16x32_bf16 v[88:91], v[52:55], v[244:247], v[88:91]
    v_mfma_f32_16x16x32_bf16 v[88:91], v[56:59], v[248:251], v[88:91]
    v_mfma_f32_16x16x32_bf16 v[88:91], v[60:63], v[252:255], v[88:91]
    v_mfma_f32_16x16x32_bf16 v[92:95], v[96:99], v[224:227], 0
    v_mfma_f32_16x16x32_bf16 v[92:95], v[100:103], v[228:231], v[92:95]
    v_mfma_f32_16x16x32_bf16 v[92:95], v[104:107], v[232:235], v[92:95]
    v_mfma_f32_16x16x32_bf16 v[92:95], v[108:111], v[236:239], v[92:95]
    v_mfma_f32_16x16x32_bf16 v[92:95], v[112:115], v[240:243], v[92:95]
    v_mfma_f32_16x16x32_bf16 v[92:95], v[116:119], v[244:247], v[92:95]
    v_mfma_f32_16x16x32_bf16 v[92:95], v[120:123], v[248:251], v[92:95]
    v_mfma_f32_16x16x32_bf16 v[92:95], v[124:127], v[252:255], v[92:95]
    s_nop 7
    v_max3_f32 v27, v88, v89, v90
    v_max_f32 v27, v27, v91
    v_max3_f32 v27, v27, v92, v93
    v_max3_f32 v27, v27, v94, v95
    v_mov_b32 v28, v27
    s_nop 1
    v_permlane16_swap_b32 v27, v28
    s_nop 1
    v_max_f32 v27, v27, v28
    v_mov_b32 v28, v27
    s_nop 1
    v_permlane32_swap_b32 v27, v28
    s_nop 1
    v_max_f32 v27, v27, v28
    v_mul_f32 v19, s28, v27
    v_sub_f32 v19, 0, v19
    s_mov_b32 s30, 65536
    s_mov_b32 s31, 49152
    s_waitcnt vmcnt(16)
    s_barrier
    ds_read_b128 v[32:35], v0 offset:16384
    ds_read_b128 v[36:39], v1 offset:16384
    ds_read_b128 v[40:43], v2 offset:16384
    ds_read_b128 v[44:47], v3 offset:16384
    v_fma_f32 v88, v88, s28, v19
    v_fma_f32 v89, v89, s28, v19
    v_exp_f32 v88, v88
    s_nop 0
    v_exp_f32 v89, v89
    s_nop 0
    v_add_f32 v23, v23, v88
    v_cvt_pk_bf16_f32 v88, v88, v89
    v_add_f32 v23, v23, v89
    v_fma_f32 v90, v90, s28, v19
    v_fma_f32 v91, v91, s28, v19
    v_exp_f32 v90, v90
    s_nop 0
    v_exp_f32 v91, v91
    s_nop 0
    s_branch L_projoin
L_pro2:
    s_mov_b32 s30, 0
    s_add_u32 m0, s29, 0
    s_nop 0
    buffer_load_dwordx4 v12, s[16:19], s30 offen offset:0 lds
    v_xor_b32 v14, 32, v12
    buffer_load_dwordx4 v14, s[16:19], s30 offen offset:1024 lds
    v_xor_b32 v14, 64, v12
    buffer_load_dwordx4 v14, s[16:19], s30 offen offset:2048 lds
    v_xor_b32 v14, 96, v12
    buffer_load_dwordx4 v14, s[16:19], s30 offen offset:3072 lds
    v_xor_b32 v70, v69, v68
    v_lshlrev_b32 v70, 4, v70
    v_lshl_add_u32 v0, v68, 9, v70
    v_xor_b32 v1, 64, v0
    v_xor_b32 v2, 128, v0
    v_xor_b32 v3, 192, v0
    v_lshrrev_b32 v70, 2, v68
    v_and_b32 v71, 3, v68
    v_lshl_add_u32 v74, v69, 2, v70
    v_and_b32 v75, 7, v74
    v_lshlrev_b32 v74, 9, v74
    v_lshl_add_u32 v74, v75, 5, v74
    v_lshl_add_u32 v74, v71, 3, v74
    v_add_u32 v4, 65536, v74
    v_xor_b32 v5, 32, v4
    v_xor_b32 v6, 64, v4
    v_xor_b32 v7, 96, v4
    v_xor_b32 v8, 128, v4
    v_xor_b32 v9, 160, v4
    v_xor_b32 v10, 192, v4
    v_xor_b32 v11, 224, v4
    v_and_b32 v70, 7, v68
    v_xor_b32 v71, v69, v68
    v_lshlrev_b32 v71, 4, v71
    v_lshl_add_u32 v71, v70, 9, v71
    v_lshl_add_u32 v15, v64, 12, v71
    v_cmp_lt_u32 s[46:47], 7, v68
    v_mov_b32 v20, 0
    v_mov_b32 v21, 0
    v_mov_b32 v22, 0
    v_mov_b32 v23, 0
    s_nop 1
    v_mfma_f32_32x32x16_bf16 a[0:15], v[20:23], v[20:23], 0
    v_mfma_f32_32x32x16_bf16 a[16:31], v[20:23], v[20:23], 0
    v_mfma_f32_32x32x16_bf16 a[32:47], v[20:23], v[20:23], 0
    v_mfma_f32_32x32x16_bf16 a[48:63], v[20:23], v[20:23], 0
    v_mfma_f32_32x32x16_bf16 a[64:79], v[20:23], v[20:23], 0
    v_mfma_f32_32x32x16_bf16 a[80:95], v[20:23], v[20:23], 0
    v_mfma_f32_32x32x16_bf16 a[96:111], v[20:23], v[20:23], 0
    v_mfma_f32_32x32x16_bf16 a[112:127], v[20:23], v[20:23], 0
    v_mfma_f32_32x32x16_bf16 a[128:143], v[20:23], v[20:23], 0
    v_mfma_f32_32x32x16_bf16 a[144:159], v[20:23], v[20:23], 0
    v_mfma_f32_32x32x16_bf16 a[160:175], v[20:23], v[20:23], 0
    v_mfma_f32_32x32x16_bf16 a[176:191], v[20:23], v[20:23], 0
    v_mfma_f32_32x32x16_bf16 a[192:207], v[20:23], v[20:23], 0
    v_mfma_f32_32x32x16_bf16 a[208:223], v[20:23], v[20:23], 0
    v_mfma_f32_32x32x16_bf16 a[224:239], v[20:23], v[20:23], 0
    v_mfma_f32_32x32x16_bf16 a[240:255], v[20:23], v[20:23], 0
    s_waitcnt vmcnt(0)
    s_mov_b32 s30, 16384
    s_add_u32 m0, s29, 16384
    s_nop 0
    buffer_load_dwordx4 v12, s[16:19], s30 offen offset:0 lds
    v_xor_b32 v14, 32, v12
    buffer_load_dwordx4 v14, s[16:19], s30 offen offset:1024 lds
    v_xor_b32 v14, 64, v12
    buffer_load_dwordx4 v14, s[16:19], s30 offen offset:2048 lds
    v_xor_b32 v14, 96, v12
    buffer_load_dwordx4 v14, s[16:19], s30 offen offset:3072 lds
    s_waitcnt vmcnt(0)
    s_lshl_b32 s45, s41, 15
    s_add_u32 m0, s29, 65536
    s_nop 0
    buffer_load_dwordx4 v26, s[12:15], s45 offen offset:0 nt lds
    v_xor_b32 v14, 32, v26
    buffer_load_dwordx4 v14, s[12:15], s45 offen offset:1024 nt lds
    v_xor_b32 v14, 64, v26
    buffer_load_dwordx4 v14, s[12:15], s45 offen offset:2048 nt lds
    v_xor_b32 v14, 96, v26
    buffer_load_dwordx4 v14, s[12:15], s45 offen offset:3072 nt lds
    s_lshl_b32 s45, s41, 15
    s_add_u32 s45, s45, 4096
    s_add_u32 m0, s29, 32768
    s_nop 0
    buffer_load_dwordx4 v27, s[12:15], s45 offen offset:0 nt lds
    v_xor_b32 v14, 32, v27
    buffer_load_dwordx4 v14, s[12:15], s45 offen offset:1024 nt lds
    v_xor_b32 v14, 64, v27
    buffer_load_dwordx4 v14, s[12:15], s45 offen offset:2048 nt lds
    v_xor_b32 v14, 96, v27
    buffer_load_dwordx4 v14, s[12:15], s45 offen offset:3072 nt lds
    s_lshl_b32 s45, s41, 15
    s_add_u32 s45, s45, 8192
    s_add_u32 m0, s29, 81920
    s_nop 0
    buffer_load_dwordx4 v26, s[12:15], s45 offen offset:0 nt lds
    v_xor_b32 v14, 32, v26
    buffer_load_dwordx4 v14, s[12:15], s45 offen offset:1024 nt lds
    v_xor_b32 v14, 64, v26
    buffer_load_dwordx4 v14, s[12:15], s45 offen offset:2048 nt lds
    v_xor_b32 v14, 96, v26
    buffer_load_dwordx4 v14, s[12:15], s45 offen offset:3072 nt lds
    s_lshl_b32 s45, s41, 15
    s_add_u32 s45, s45, 12288
    s_add_u32 m0, s29, 49152
    s_nop 0
    buffer_load_dwordx4 v27, s[12:15], s45 offen offset:0 nt lds
    v_xor_b32 v14, 32, v27
    buffer_load_dwordx4 v14, s[12:15], s45 offen offset:1024 nt lds
    v_xor_b32 v14, 64, v27
    buffer_load_dwordx4 v14, s[12:15], s45 offen offset:2048 nt lds
    v_xor_b32 v14, 96, v27
    buffer_load_dwordx4 v14, s[12:15], s45 offen offset:3072 nt lds
    s_lshl_b32 s45, s41, 15
    s_add_u32 s45, s45, 16384
    s_add_u32 m0, s29, 98304
    s_nop 0
    buffer_load_dwordx4 v26, s[12:15], s45 offen offset:0 nt lds
    v_xor_b32 v14, 32, v26
    buffer_load_dwordx4 v14, s[12:15], s45 offen offset:1024 nt lds
    v_xor_b32 v14, 64, v26
    buffer_load_dwordx4 v14, s[12:15], s45 offen offset:2048 nt lds
    v_xor_b32 v14, 96, v26
    buffer_load_dwordx4 v14, s[12:15], s45 offen offset:3072 nt lds
    s_lshl_b32 s45, s41, 15
    s_add_u32 s45, s45, 20480
    s_add_u32 m0, s29, 114688
    s_nop 0
    buffer_load_dwordx4 v27, s[12:15], s45 offen offset:0 nt lds
    v_xor_b32 v14, 32, v27
    buffer_load_dwordx4 v14, s[12:15], s45 offen offset:1024 nt lds
    v_xor_b32 v14, 64, v27
    buffer_load_dwordx4 v14, s[12:15], s45 offen offset:2048 nt lds
    v_xor_b32 v14, 96, v27
    buffer_load_dwordx4 v14, s[12:15], s45 offen offset:3072 nt lds
    s_lshl_b32 s45, s41, 15
    s_add_u32 s45, s45, 24576
    s_add_u32 m0, s29, 131072
    s_nop 0
    buffer_load_dwordx4 v26, s[12:15], s45 offen offset:0 nt lds
    v_xor_b32 v14, 32, v26
    buffer_load_dwordx4 v14, s[12:15], s45 offen offset:1024 nt lds
    v_xor_b32 v14, 64, v26
    buffer_load_dwordx4 v14, s[12:15], s45 offen offset:2048 nt lds
    v_xor_b32 v14, 96, v26
    buffer_load_dwordx4 v14, s[12:15], s45 offen offset:3072 nt lds
    s_lshl_b32 s45, s41, 15
    s_add_u32 s45, s45, 28672
    s_add_u32 m0, s29, 147456
    s_nop 0
    buffer_load_dwordx4 v27, s[12:15], s45 offen offset:0 nt lds
    v_xor_b32 v14, 32, v27
    buffer_load_dwordx4 v14, s[12:15], s45 offen offset:1024 nt lds
    v_xor_b32 v14, 64, v27
    buffer_load_dwordx4 v14, s[12:15], s45 offen offset:2048 nt lds
    v_xor_b32 v14, 96, v27
    buffer_load_dwordx4 v14, s[12:15], s45 offen offset:3072 nt lds
    s_barrier
    ds_read_b128 v[32:35], v0 offset:0
    ds_read_b128 v[36:39], v1 offset:0
    ds_read_b128 v[40:43], v2 offset:0
    ds_read_b128 v[44:47], v3 offset:0
    ds_read_b128 v[48:51], v0 offset:256
    ds_read_b128 v[52:55], v1 offset:256
    ds_read_b128 v[56:59], v2 offset:256
    ds_read_b128 v[60:63], v3 offset:256
    ds_read_b128 v[96:99], v0 offset:8192
    ds_read_b128 v[100:103], v1 offset:8192
    ds_read_b128 v[104:107], v2 offset:8192
    ds_read_b128 v[108:111], v3 offset:8192
    ds_read_b128 v[112:115], v0 offset:8448
    ds_read_b128 v[116:119], v1 offset:8448
    ds_read_b128 v[120:123], v2 offset:8448
    ds_read_b128 v[124:127], v3 offset:8448
    v_mov_b32 v28, 65536
    v_mov_b32 v29, 32768
    v_cndmask_b32 v28, v28, v29, s[46:47]
    v_add_u32 v28, v28, v15
    v_xor_b32 v29, 64, v28
    v_xor_b32 v30, 128, v28
    v_xor_b32 v31, 192, v28
    s_waitcnt vmcnt(24)
    ds_read_b128 v[128:131], v28 offset:0
    ds_read_b128 v[132:135], v29 offset:0
    ds_read_b128 v[136:139], v30 offset:0
    ds_read_b128 v[140:143], v31 offset:0
    ds_read_b128 v[144:147], v28 offset:256
    ds_read_b128 v[148:151], v29 offset:256
    ds_read_b128 v[152:155], v30 offset:256
    ds_read_b128 v[156:159], v31 offset:256
    s_waitcnt lgkmcnt(0)
    v_mfma_f32_16x16x32_bf16 v[64:67], v[32:35], v[128:131], 0
    v_mfma_f32_16x16x32_bf16 v[64:67], v[36:39], v[132:135], v[64:67]
    v_mfma_f32_16x16x32_bf16 v[64:67], v[40:43], v[136:139], v[64:67]
    v_mfma_f32_16x16x32_bf16 v[64:67], v[44:47], v[140:143], v[64:67]
    v_mfma_f32_16x16x32_bf16 v[64:67], v[48:51], v[144:147], v[64:67]
    v_mfma_f32_16x16x32_bf16 v[64:67], v[52:55], v[148:151], v[64:67]
    v_mfma_f32_16x16x32_bf16 v[64:67], v[56:59], v[152:155], v[64:67]
    v_mfma_f32_16x16x32_bf16 v[64:67], v[60:63], v[156:159], v[64:67]
    v_mfma_f32_16x16x32_bf16 v[68:71], v[96:99], v[128:131], 0
    v_mfma_f32_16x16x32_bf16 v[68:71], v[100:103], v[132:135], v[68:71]
    v_mfma_f32_16x16x32_bf16 v[68:71], v[104:107], v[136:139], v[68:71]
    v_mfma_f32_16x16x32_bf16 v[68:71], v[108:111], v[140:143], v[68:71]
    v_mfma_f32_16x16x32_bf16 v[68:71], v[112:115], v[144:147], v[68:71]
    v_mfma_f32_16x16x32_bf16 v[68:71], v[116:119], v[148:151], v[68:71]
    v_mfma_f32_16x16x32_bf16 v[68:71], v[120:123], v[152:155], v[68:71]
    v_mfma_f32_16x16x32_bf16 v[68:71], v[124:127], v[156:159], v[68:71]
    s_nop 7
    v_max3_f32 v24, v64, v65, v66
    v_max_f32 v24, v24, v67
    v_max3_f32 v24, v24, v68, v69
    v_max3_f32 v24, v24, v70, v71
    v_mov_b32 v28, v24
    s_nop 1
    v_permlane16_swap_b32 v24, v28
    s_nop 1
    v_max_f32 v24, v24, v28
    v_mov_b32 v28, v24
    s_nop 1
    v_permlane32_swap_b32 v24, v28
    s_nop 1
    v_max_f32 v24, v24, v28
    v_mul_f32 v16, s28, v24
    v_sub_f32 v16, 0, v16
    v_fma_f32 v64, v64, s28, v16
    v_fma_f32 v65, v65, s28, v16
    v_exp_f32 v64, v64
    s_nop 0
    v_add_f32 v20, v20, v64
    v_fma_f32 v66, v66, s28, v16
    v_exp_f32 v65, v65
    s_nop 0
    v_cvt_pk_bf16_f32 v64, v64, v65
    v_add_f32 v20, v20, v65
    v_fma_f32 v67, v67, s28, v16
    v_exp_f32 v66, v66
    s_nop 0
    v_exp_f32 v67, v67
    s_nop 0
    v_add_f32 v20, v20, v66
    v_cvt_pk_bf16_f32 v65, v66, v67
    v_add_f32 v20, v20, v67
    v_mov_b32 v28, 81920
    v_mov_b32 v29, 49152
    v_cndmask_b32 v28, v28, v29, s[46:47]
    v_add_u32 v28, v28, v15
    v_xor_b32 v29, 64, v28
    v_xor_b32 v30, 128, v28
    v_xor_b32 v31, 192, v28
    s_waitcnt vmcnt(16)
    ds_read_b128 v[160:163], v28 offset:0
    ds_read_b128 v[164:167], v29 offset:0
    ds_read_b128 v[168:171], v30 offset:0
    ds_read_b128 v[172:175], v31 offset:0
    ds_read_b128 v[176:179], v28 offset:256
    ds_read_b128 v[180:183], v29 offset:256
    ds_read_b128 v[184:187], v30 offset:256
    ds_read_b128 v[188:191], v31 offset:256
    s_waitcnt lgkmcnt(0)
    s_mov_b32 s31, 0
    s_add_u32 m0, s29, 65536
    s_nop 0
    buffer_load_dwordx4 v13, s[20:23], s31 offen offset:0 lds
    v_xor_b32 v14, 64, v13
    buffer_load_dwordx4 v14, s[20:23], s31 offen offset:1024 lds
    v_xor_b32 v14, 128, v13
    buffer_load_dwordx4 v14, s[20:23], s31 offen offset:2048 lds
    v_xor_b32 v14, 192, v13
    buffer_load_dwordx4 v14, s[20:23], s31 offen offset:3072 lds
    v_mfma_f32_16x16x32_bf16 v[72:75], v[32:35], v[160:163], 0
    v_mfma_f32_16x16x32_bf16 v[72:75], v[36:39], v[164:167], v[72:75]
    v_mfma_f32_16x16x32_bf16 v[72:75], v[40:43], v[168:171], v[72:75]
    v_mfma_f32_16x16x32_bf16 v[72:75], v[44:47], v[172:175], v[72:75]
    v_mfma_f32_16x16x32_bf16 v[72:75], v[48:51], v[176:179], v[72:75]
    v_mfma_f32_16x16x32_bf16 v[72:75], v[52:55], v[180:183], v[72:75]
    v_mfma_f32_16x16x32_bf16 v[72:75], v[56:59], v[184:187], v[72:75]
    v_mfma_f32_16x16x32_bf16 v[72:75], v[60:63], v[188:191], v[72:75]
    v_mfma_f32_16x16x32_bf16 v[76:79], v[96:99], v[160:163], 0
    v_mfma_f32_16x16x32_bf16 v[76:79], v[100:103], v[164:167], v[76:79]
    v_mfma_f32_16x16x32_bf16 v[76:79], v[104:107], v[168:171], v[76:79]
    v_mfma_f32_16x16x32_bf16 v[76:79], v[108:111], v[172:175], v[76:79]
    v_mfma_f32_16x16x32_bf16 v[76:79], v[112:115], v[176:179], v[76:79]
    v_mfma_f32_16x16x32_bf16 v[76:79], v[116:119], v[180:183], v[76:79]
    v_mfma_f32_16x16x32_bf16 v[76:79], v[120:123], v[184:187], v[76:79]
    v_mfma_f32_16x16x32_bf16 v[76:79], v[124:127], v[188:191], v[76:79]
    s_nop 7
    v_max3_f32 v25, v72, v73, v74
    v_max_f32 v25, v25, v75
    v_max3_f32 v25, v25, v76, v77
    v_max3_f32 v25, v25, v78, v79
    v_mov_b32 v28, v25
    s_nop 1
    v_permlane16_swap_b32 v25, v28
    s_nop 1
    v_max_f32 v25, v25, v28
    v_mov_b32 v28, v25
    s_nop 1
    v_permlane32_swap_b32 v25, v28
    s_nop 1
    v_max_f32 v25, v25, v28
    v_mul_f32 v17, s28, v25
    v_sub_f32 v17, 0, v17
    v_fma_f32 v72, v72, s28, v17
    v_fma_f32 v73, v73, s28, v17
    v_exp_f32 v72, v72
    s_nop 0
    v_exp_f32 v73, v73
    s_nop 0
    v_add_f32 v21, v21, v72
    v_cvt_pk_bf16_f32 v72, v72, v73
    v_add_f32 v21, v21, v73
    v_fma_f32 v74, v74, s28, v17
    v_exp_f32 v74, v74
    s_nop 0
    v_fma_f32 v75, v75, s28, v17
    v_add_f32 v21, v21, v74
    v_exp_f32 v75, v75
    s_nop 0
    v_cvt_pk_bf16_f32 v73, v74, v75
    v_add_f32 v21, v21, v75
    v_mov_b32 v28, 98304
    v_mov_b32 v29, 114688
    v_cndmask_b32 v28, v28, v29, s[46:47]
    v_add_u32 v28, v28, v15
    v_xor_b32 v29, 64, v28
    v_xor_b32 v30, 128, v28
    v_xor_b32 v31, 192, v28
    s_waitcnt vmcnt(12)
    ds_read_b128 v[192:195], v28 offset:0
    ds_read_b128 v[196:199], v29 offset:0
    ds_read_b128 v[200:203], v30 offset:0
    ds_read_b128 v[204:207], v31 offset:0
    ds_read_b128 v[208:211], v28 offset:256
    ds_read_b128 v[212:215], v29 offset:256
    ds_read_b128 v[216:219], v30 offset:256
    ds_read_b128 v[220:223], v31 offset:256
    s_waitcnt lgkmcnt(0)
    s_mov_b32 s30, 32768
    s_add_u32 m0, s29, 32768
    s_nop 0
    buffer_load_dwordx4 v12, s[16:19], s30 offen offset:0 lds
    v_xor_b32 v14, 32, v12
    buffer_load_dwordx4 v14, s[16:19], s30 offen offset:1024 lds
    v_xor_b32 v14, 64, v12
    buffer_load_dwordx4 v14, s[16:19], s30 offen offset:2048 lds
    v_xor_b32 v14, 96, v12
    buffer_load_dwordx4 v14, s[16:19], s30 offen offset:3072 lds
    v_mfma_f32_16x16x32_bf16 v[80:83], v[32:35], v[192:195], 0
    v_mfma_f32_16x16x32_bf16 v[80:83], v[36:39], v[196:199], v[80:83]
    v_mfma_f32_16x16x32_bf16 v[80:83], v[40:43], v[200:203], v[80:83]
    v_mfma_f32_16x16x32_bf16 v[80:83], v[44:47], v[204:207], v[80:83]
    v_mfma_f32_16x16x32_bf16 v[80:83], v[48:51], v[208:211], v[80:83]
    v_mfma_f32_16x16x32_bf16 v[80:83], v[52:55], v[212:215], v[80:83]
    v_mfma_f32_16x16x32_bf16 v[80:83], v[56:59], v[216:219], v[80:83]
    v_mfma_f32_16x16x32_bf16 v[80:83], v[60:63], v[220:223], v[80:83]
    v_mfma_f32_16x16x32_bf16 v[84:87], v[96:99], v[192:195], 0
    v_mfma_f32_16x16x32_bf16 v[84:87], v[100:103], v[196:199], v[84:87]
    v_mfma_f32_16x16x32_bf16 v[84:87], v[104:107], v[200:203], v[84:87]
    v_mfma_f32_16x16x32_bf16 v[84:87], v[108:111], v[204:207], v[84:87]
    v_mfma_f32_16x16x32_bf16 v[84:87], v[112:115], v[208:211], v[84:87]
    v_mfma_f32_16x16x32_bf16 v[84:87], v[116:119], v[212:215], v[84:87]
    v_mfma_f32_16x16x32_bf16 v[84:87], v[120:123], v[216:219], v[84:87]
    v_mfma_f32_16x16x32_bf16 v[84:87], v[124:127], v[220:223], v[84:87]
    s_nop 7
    v_max3_f32 v26, v80, v81, v82
    v_max_f32 v26, v26, v83
    v_max3_f32 v26, v26, v84, v85
    v_max3_f32 v26, v26, v86, v87
    v_mov_b32 v28, v26
    s_nop 1
    v_permlane16_swap_b32 v26, v28
    s_nop 1
    v_max_f32 v26, v26, v28
    v_mov_b32 v28, v26
    s_nop 1
    v_permlane32_swap_b32 v26, v28
    s_nop 1
    v_max_f32 v26, v26, v28
    v_mul_f32 v18, s28, v26
    v_sub_f32 v18, 0, v18
    v_fma_f32 v80, v80, s28, v18
    v_fma_f32 v81, v81, s28, v18
    v_exp_f32 v80, v80
    s_nop 0
    v_exp_f32 v81, v81
    s_nop 0
    v_add_f32 v22, v22, v80
    v_cvt_pk_bf16_f32 v80, v80, v81
    v_add_f32 v22, v22, v81
    v_fma_f32 v82, v82, s28, v18
    v_exp_f32 v82, v82
    s_nop 0
    v_fma_f32 v83, v83, s28, v18
    v_add_f32 v22, v22, v82
    v_exp_f32 v83, v83
    s_nop 0
    v_cvt_pk_bf16_f32 v81, v82, v83
    v_add_f32 v22, v22, v83
    v_mov_b32 v28, 131072
    v_mov_b32 v29, 147456
    v_cndmask_b32 v28, v28, v29, s[46:47]
    v_add_u32 v28, v28, v15
    v_xor_b32 v29, 64, v28
    v_xor_b32 v30, 128, v28
    v_xor_b32 v31, 192, v28
    s_waitcnt vmcnt(8)
    ds_read_b128 v[224:227], v28 offset:0
    ds_read_b128 v[228:231], v29 offset:0
    ds_read_b128 v[232:235], v30 offset:0
    ds_read_b128 v[236:239], v31 offset:0
    ds_read_b128 v[240:243], v28 offset:256
    ds_read_b128 v[244:247], v29 offset:256
    ds_read_b128 v[248:251], v30 offset:256
    ds_read_b128 v[252:255], v31 offset:256
    s_waitcnt lgkmcnt(0)
    s_mov_b32 s31, 16384
    s_add_u32 m0, s29, 81920
    s_nop 0
    buffer_load_dwordx4 v13, s[20:23], s31 offen offset:0 lds
    v_xor_b32 v14, 64, v13
    buffer_load_dwordx4 v14, s[20:23], s31 offen offset:1024 lds
    v_xor_b32 v14, 128, v13
    buffer_load_dwordx4 v14, s[20:23], s31 offen offset:2048 lds
    v_xor_b32 v14, 192, v13
    buffer_load_dwordx4 v14, s[20:23], s31 offen offset:3072 lds
    s_mov_b32 s30, 49152
    s_add_u32 m0, s29, 49152
    s_nop 0
    buffer_load_dwordx4 v12, s[16:19], s30 offen offset:0 lds
    v_xor_b32 v14, 32, v12
    buffer_load_dwordx4 v14, s[16:19], s30 offen offset:1024 lds
    v_xor_b32 v14, 64, v12
    buffer_load_dwordx4 v14, s[16:19], s30 offen offset:2048 lds
    v_xor_b32 v14, 96, v12
    buffer_load_dwordx4 v14, s[16:19], s30 offen offset:3072 lds
    s_mov_b32 s31, 32768
    s_add_u32 m0, s29, 98304
    s_nop 0
    buffer_load_dwordx4 v13, s[20:23], s31 offen offset:0 lds
    v_xor_b32 v14, 64, v13
    buffer_load_dwordx4 v14, s[20:23], s31 offen offset:1024 lds
    v_xor_b32 v14, 128, v13
    buffer_load_dwordx4 v14, s[20:23], s31 offen offset:2048 lds
    v_xor_b32 v14, 192, v13
    buffer_load_dwordx4 v14, s[20:23], s31 offen offset:3072 lds
    v_mfma_f32_16x16x32_bf16 v[88:91], v[32:35], v[224:227], 0
    v_mfma_f32_16x16x32_bf16 v[88:91], v[36:39], v[228:231], v[88:91]
    v_mfma_f32_16x16x32_bf16 v[88:91], v[40:43], v[232:235], v[88:91]
    v_mfma_f32_16x16x32_bf16 v[88:91], v[44:47], v[236:239], v[88:91]
    v_mfma_f32_16x16x32_bf16 v[88:91], v[48:51], v[240:243], v[88:91]
    v_mfma_f32_16x16x32_bf16 v[88:91], v[52:55], v[244:247], v[88:91]
    v_mfma_f32_16x16x32_bf16 v[88:91], v[56:59], v[248:251], v[88:91]
    v_mfma_f32_16x16x32_bf16 v[88:91], v[60:63], v[252:255], v[88:91]
    v_mfma_f32_16x16x32_bf16 v[92:95], v[96:99], v[224:227], 0
    v_mfma_f32_16x16x32_bf16 v[92:95], v[100:103], v[228:231], v[92:95]
    v_mfma_f32_16x16x32_bf16 v[92:95], v[104:107], v[232:235], v[92:95]
    v_mfma_f32_16x16x32_bf16 v[92:95], v[108:111], v[236:239], v[92:95]
    v_mfma_f32_16x16x32_bf16 v[92:95], v[112:115], v[240:243], v[92:95]
    v_mfma_f32_16x16x32_bf16 v[92:95], v[116:119], v[244:247], v[92:95]
    v_mfma_f32_16x16x32_bf16 v[92:95], v[120:123], v[248:251], v[92:95]
    v_mfma_f32_16x16x32_bf16 v[92:95], v[124:127], v[252:255], v[92:95]
    s_nop 7
    v_max3_f32 v27, v88, v89, v90
    v_max_f32 v27, v27, v91
    v_max3_f32 v27, v27, v92, v93
    v_max3_f32 v27, v27, v94, v95
    v_mov_b32 v28, v27
    s_nop 1
    v_permlane16_swap_b32 v27, v28
    s_nop 1
    v_max_f32 v27, v27, v28
    v_mov_b32 v28, v27
    s_nop 1
    v_permlane32_swap_b32 v27, v28
    s_nop 1
    v_max_f32 v27, v27, v28
    v_mul_f32 v19, s28, v27
    v_sub_f32 v19, 0, v19
    s_mov_b32 s30, 65536
    s_mov_b32 s31, 49152
    s_waitcnt vmcnt(16)
    s_barrier
    ds_read_b128 v[32:35], v0 offset:16384
    ds_read_b128 v[36:39], v1 offset:16384
    ds_read_b128 v[40:43], v2 offset:16384
    ds_read_b128 v[44:47], v3 offset:16384
    v_fma_f32 v88, v88, s28, v19
    v_fma_f32 v89, v89, s28, v19
    v_exp_f32 v88, v88
    s_nop 0
    v_exp_f32 v89, v89
    s_nop 0
    v_add_f32 v23, v23, v88
    v_cvt_pk_bf16_f32 v88, v88, v89
    v_add_f32 v23, v23, v89
    v_fma_f32 v90, v90, s28, v19
    v_fma_f32 v91, v91, s28, v19
    v_exp_f32 v90, v90
    s_nop 0
    v_exp_f32 v91, v91
    s_nop 0
L_projoin:
    s_mov_b32 s32, 7
L_loop:
    s_waitcnt lgkmcnt(0)
    v_mfma_f32_16x16x32_bf16 v[96:99], v[32:35], v[128:131], 0
    ds_read_b128 v[48:51], v0 offset:16640
    v_add_f32 v23, v23, v90
    v_mfma_f32_16x16x32_bf16 v[96:99], v[36:39], v[132:135], v[96:99]
    ds_read_b128 v[52:55], v1 offset:16640
    v_cvt_pk_bf16_f32 v89, v90, v91
    v_mfma_f32_16x16x32_bf16 v[96:99], v[40:43], v[136:139], v[96:99]
    ds_read_b128 v[56:59], v2 offset:16640
    v_add_f32 v23, v23, v91
    v_mfma_f32_16x16x32_bf16 v[96:99], v[44:47], v[140:143], v[96:99]
    ds_read_b128 v[60:63], v3 offset:16640
    v_fma_f32 v68, v68, s28, v16
    v_mfma_f32_16x16x32_bf16 v[104:107], v[32:35], v[160:163], 0
    v_exp_f32 v68, v68
    v_mfma_f32_16x16x32_bf16 v[104:107], v[36:39], v[164:167], v[104:107]
    s_add_u32 m0, s29, 0
    s_nop 0
    buffer_load_dwordx4 v12, s[16:19], s30 offen offset:0 lds
    v_mfma_f32_16x16x32_bf16 v[104:107], v[40:43], v[168:171], v[104:107]
    v_fma_f32 v69, v69, s28, v16
    v_add_f32 v20, v20, v68
    v_mfma_f32_16x16x32_bf16 v[104:107], v[44:47], v[172:175], v[104:107]
    v_exp_f32 v69, v69
    v_mfma_f32_16x16x32_bf16 v[112:115], v[32:35], v[192:195], 0
    v_cvt_pk_bf16_f32 v66, v68, v69
    v_add_f32 v20, v20, v69
    v_mfma_f32_16x16x32_bf16 v[112:115], v[36:39], v[196:199], v[112:115]
    v_fma_f32 v76, v76, s28, v17
    v_fma_f32 v77, v77, s28, v17
    v_mfma_f32_16x16x32_bf16 v[112:115], v[40:43], v[200:203], v[112:115]
    v_exp_f32 v76, v76
    v_mfma_f32_16x16x32_bf16 v[112:115], v[44:47], v[204:207], v[112:115]
    v_exp_f32 v77, v77
    v_mfma_f32_16x16x32_bf16 v[120:123], v[32:35], v[224:227], 0
    v_add_f32 v21, v21, v76
    v_cvt_pk_bf16_f32 v74, v76, v77
    v_mfma_f32_16x16x32_bf16 v[120:123], v[36:39], v[228:231], v[120:123]
    v_add_f32 v21, v21, v77
    v_fma_f32 v84, v84, s28, v18
    v_mfma_f32_16x16x32_bf16 v[120:123], v[40:43], v[232:235], v[120:123]
    v_exp_f32 v84, v84
    v_mfma_f32_16x16x32_bf16 v[120:123], v[44:47], v[236:239], v[120:123]
    v_fma_f32 v85, v85, s28, v18
    v_add_f32 v22, v22, v84
    s_waitcnt lgkmcnt(0)
    v_mfma_f32_16x16x32_bf16 v[96:99], v[48:51], v[144:147], v[96:99]
    ds_read_b128 v[32:35], v0 offset:24576
    v_xor_b32 v14, 32, v12
    v_mfma_f32_16x16x32_bf16 v[96:99], v[52:55], v[148:151], v[96:99]
    ds_read_b128 v[36:39], v1 offset:24576
    v_fma_f32 v92, v92, s28, v19
    v_mfma_f32_16x16x32_bf16 v[96:99], v[56:59], v[152:155], v[96:99]
    ds_read_b128 v[40:43], v2 offset:24576
    v_fma_f32 v93, v93, s28, v19
    v_mfma_f32_16x16x32_bf16 v[96:99], v[60:63], v[156:159], v[96:99]
    ds_read_b128 v[44:47], v3 offset:24576
    v_fma_f32 v70, v70, s28, v16
    v_mfma_f32_16x16x32_bf16 v[104:107], v[48:51], v[176:179], v[104:107]
    buffer_load_dwordx4 v14, s[16:19], s30 offen offset:1024 lds
    v_mfma_f32_16x16x32_bf16 v[104:107], v[52:55], v[180:183], v[104:107]
    v_exp_f32 v85, v85
    v_mfma_f32_16x16x32_bf16 v[104:107], v[56:59], v[184:187], v[104:107]
    v_exp_f32 v92, v92
    v_mfma_f32_16x16x32_bf16 v[104:107], v[60:63], v[188:191], v[104:107]
    v_exp_f32 v93, v93
    v_mfma_f32_16x16x32_bf16 v[112:115], v[48:51], v[208:211], v[112:115]
    v_exp_f32 v70, v70
    v_mfma_f32_16x16x32_bf16 v[112:115], v[52:55], v[212:215], v[112:115]
    v_cvt_pk_bf16_f32 v82, v84, v85
    v_add_f32 v22, v22, v85
    v_mfma_f32_16x16x32_bf16 v[112:115], v[56:59], v[216:219], v[112:115]
    v_add_f32 v23, v23, v92
    v_cvt_pk_bf16_f32 v90, v92, v93
    v_mfma_f32_16x16x32_bf16 v[112:115], v[60:63], v[220:223], v[112:115]
    v_xor_b32 v14, 64, v12
    v_add_f32 v23, v23, v93
    v_mfma_f32_16x16x32_bf16 v[120:123], v[48:51], v[240:243], v[120:123]
    buffer_load_dwordx4 v14, s[16:19], s30 offen offset:2048 lds
    v_mfma_f32_16x16x32_bf16 v[120:123], v[52:55], v[244:247], v[120:123]
    v_fma_f32 v71, v71, s28, v16
    v_add_f32 v20, v20, v70
    v_mfma_f32_16x16x32_bf16 v[120:123], v[56:59], v[248:251], v[120:123]
    v_exp_f32 v71, v71
    v_mfma_f32_16x16x32_bf16 v[120:123], v[60:63], v[252:255], v[120:123]
    v_cvt_pk_bf16_f32 v67, v70, v71
    v_add_f32 v20, v20, v71
    s_waitcnt lgkmcnt(0)
    v_mfma_f32_16x16x32_bf16 v[100:103], v[32:35], v[128:131], 0
    ds_read_b128 v[48:51], v0 offset:24832
    v_fma_f32 v78, v78, s28, v17
    v_mfma_f32_16x16x32_bf16 v[100:103], v[36:39], v[132:135], v[100:103]
    ds_read_b128 v[52:55], v1 offset:24832
    v_fma_f32 v79, v79, s28, v17
    v_mfma_f32_16x16x32_bf16 v[100:103], v[40:43], v[136:139], v[100:103]
    ds_read_b128 v[56:59], v2 offset:24832
    v_fma_f32 v86, v86, s28, v18
    v_mfma_f32_16x16x32_bf16 v[100:103], v[44:47], v[140:143], v[100:103]
    ds_read_b128 v[60:63], v3 offset:24832
    v_fma_f32 v87, v87, s28, v18
    v_mfma_f32_16x16x32_bf16 v[108:111], v[32:35], v[160:163], 0
    v_exp_f32 v78, v78
    v_mfma_f32_16x16x32_bf16 v[108:111], v[36:39], v[164:167], v[108:111]
    v_exp_f32 v79, v79
    v_mfma_f32_16x16x32_bf16 v[108:111], v[40:43], v[168:171], v[108:111]
    v_xor_b32 v14, 96, v12
    v_add_f32 v21, v21, v78
    v_mfma_f32_16x16x32_bf16 v[108:111], v[44:47], v[172:175], v[108:111]
    buffer_load_dwordx4 v14, s[16:19], s30 offen offset:3072 lds
    s_add_u32 s30, s30, 16384
    v_mfma_f32_16x16x32_bf16 v[116:119], v[32:35], v[192:195], 0
    v_exp_f32 v86, v86
    v_mfma_f32_16x16x32_bf16 v[116:119], v[36:39], v[196:199], v[116:119]
    v_exp_f32 v87, v87
    v_mfma_f32_16x16x32_bf16 v[116:119], v[40:43], v[200:203], v[116:119]
    v_cvt_pk_bf16_f32 v75, v78, v79
    v_add_f32 v21, v21, v79
    v_mfma_f32_16x16x32_bf16 v[116:119], v[44:47], v[204:207], v[116:119]
    v_add_f32 v22, v22, v86
    v_cvt_pk_bf16_f32 v83, v86, v87
    v_mfma_f32_16x16x32_bf16 v[124:127], v[32:35], v[224:227], 0
    v_add_f32 v22, v22, v87
    v_fma_f32 v94, v94, s28, v19
    v_mfma_f32_16x16x32_bf16 v[124:127], v[36:39], v[228:231], v[124:127]
    v_exp_f32 v94, v94
    v_mfma_f32_16x16x32_bf16 v[124:127], v[40:43], v[232:235], v[124:127]
    v_fma_f32 v95, v95, s28, v19
    v_add_f32 v23, v23, v94
    v_mfma_f32_16x16x32_bf16 v[124:127], v[44:47], v[236:239], v[124:127]
    v_exp_f32 v95, v95
    s_waitcnt lgkmcnt(0)
    v_mfma_f32_16x16x32_bf16 v[100:103], v[48:51], v[144:147], v[100:103]
    ds_read_b64_tr_b16 v[32:33], v4 offset:0
    v_cvt_pk_bf16_f32 v91, v94, v95
    v_mfma_f32_16x16x32_bf16 v[100:103], v[52:55], v[148:151], v[100:103]
    ds_read_b64_tr_b16 v[34:35], v4 offset:8192
    v_add_f32 v23, v23, v95
    v_mfma_f32_16x16x32_bf16 v[100:103], v[56:59], v[152:155], v[100:103]
    ds_read_b64_tr_b16 v[36:37], v5 offset:0
    v_max3_f32 v24, v96, v97, v98
    s_waitcnt vmcnt(12)
    s_barrier
    v_mfma_f32_16x16x32_bf16 v[100:103], v[60:63], v[156:159], v[100:103]
    ds_read_b64_tr_b16 v[38:39], v5 offset:8192
    v_max3_f32 v25, v104, v105, v106
    v_mfma_f32_16x16x32_bf16 v[108:111], v[48:51], v[176:179], v[108:111]
    ds_read_b64_tr_b16 v[40:41], v6 offset:0
    v_max3_f32 v26, v112, v113, v114
    v_mfma_f32_16x16x32_bf16 v[108:111], v[52:55], v[180:183], v[108:111]
    ds_read_b64_tr_b16 v[42:43], v6 offset:8192
    v_max3_f32 v27, v120, v121, v122
    v_mfma_f32_16x16x32_bf16 v[108:111], v[56:59], v[184:187], v[108:111]
    ds_read_b64_tr_b16 v[44:45], v7 offset:0
    v_max_f32 v24, v24, v99
    v_mfma_f32_16x16x32_bf16 v[108:111], v[60:63], v[188:191], v[108:111]
    ds_read_b64_tr_b16 v[46:47], v7 offset:8192
    v_max_f32 v25, v25, v107
    v_mfma_f32_16x16x32_bf16 v[116:119], v[48:51], v[208:211], v[116:119]
    v_max_f32 v26, v26, v115
    v_max_f32 v27, v27, v123
    v_mfma_f32_16x16x32_bf16 v[116:119], v[52:55], v[212:215], v[116:119]
    v_mfma_f32_16x16x32_bf16 v[116:119], v[56:59], v[216:219], v[116:119]
    v_mfma_f32_16x16x32_bf16 v[116:119], v[60:63], v[220:223], v[116:119]
    v_mfma_f32_16x16x32_bf16 v[124:127], v[48:51], v[240:243], v[124:127]
    v_mfma_f32_16x16x32_bf16 v[124:127], v[52:55], v[244:247], v[124:127]
    v_mfma_f32_16x16x32_bf16 v[124:127], v[56:59], v[248:251], v[124:127]
    v_mfma_f32_16x16x32_bf16 v[124:127], v[60:63], v[252:255], v[124:127]
    s_waitcnt lgkmcnt(0)
    v_mfma_f32_16x16x32_bf16 a[0:3], v[32:35], v[64:67], a[0:3]
    ds_read_b64_tr_b16 v[48:49], v8 offset:0
    v_mfma_f32_16x16x32_bf16 a[4:7], v[36:39], v[64:67], a[4:7]
    ds_read_b64_tr_b16 v[50:51], v8 offset:8192
    v_mfma_f32_16x16x32_bf16 a[8:11], v[40:43], v[64:67], a[8:11]
    ds_read_b64_tr_b16 v[52:53], v9 offset:0
    v_max3_f32 v24, v24, v100, v101
    v_mfma_f32_16x16x32_bf16 a[12:15], v[44:47], v[64:67], a[12:15]
    ds_read_b64_tr_b16 v[54:55], v9 offset:8192
    v_max3_f32 v25, v25, v108, v109
    v_mfma_f32_16x16x32_bf16 a[64:67], v[32:35], v[72:75], a[64:67]
    ds_read_b64_tr_b16 v[56:57], v10 offset:0
    v_max3_f32 v26, v26, v116, v117
    v_mfma_f32_16x16x32_bf16 a[68:71], v[36:39], v[72:75], a[68:71]
    ds_read_b64_tr_b16 v[58:59], v10 offset:8192
    v_max3_f32 v27, v27, v124, v125
    v_mfma_f32_16x16x32_bf16 a[72:75], v[40:43], v[72:75], a[72:75]
    ds_read_b64_tr_b16 v[60:61], v11 offset:0
    v_max3_f32 v24, v24, v102, v103
    v_mfma_f32_16x16x32_bf16 a[76:79], v[44:47], v[72:75], a[76:79]
    ds_read_b64_tr_b16 v[62:63], v11 offset:8192
    v_max3_f32 v25, v25, v110, v111
    v_mfma_f32_16x16x32_bf16 a[128:131], v[32:35], v[80:83], a[128:131]
    v_max3_f32 v26, v26, v118, v119
    v_max3_f32 v27, v27, v126, v127
    v_mfma_f32_16x16x32_bf16 a[132:135], v[36:39], v[80:83], a[132:135]
    v_fma_f32 v28, v24, s28, v16
    v_fma_f32 v29, v25, s28, v17
    v_mfma_f32_16x16x32_bf16 a[136:139], v[40:43], v[80:83], a[136:139]
    v_fma_f32 v30, v26, s28, v18
    v_fma_f32 v31, v27, s28, v19
    v_mfma_f32_16x16x32_bf16 a[140:143], v[44:47], v[80:83], a[140:143]
    v_max3_f32 v28, v28, v29, v30
    v_max_f32 v28, v28, v31
    v_mfma_f32_16x16x32_bf16 a[192:195], v[32:35], v[88:91], a[192:195]
    v_cmp_lt_f32 vcc, 0x41000000, v28
    s_cbranch_vccnz L_skipA_0_stub
L_skipA_0:
    v_mfma_f32_16x16x32_bf16 a[196:199], v[36:39], v[88:91], a[196:199]
    v_fma_f32 v96, v96, s28, v16
    v_fma_f32 v97, v97, s28, v16
    v_mfma_f32_16x16x32_bf16 a[200:203], v[40:43], v[88:91], a[200:203]
    s_add_u32 m0, s29, 114688
    s_nop 0
    buffer_load_dwordx4 v13, s[20:23], s31 offen offset:0 lds
    v_mfma_f32_16x16x32_bf16 a[204:207], v[44:47], v[88:91], a[204:207]
    v_exp_f32 v96, v96
    s_waitcnt lgkmcnt(0)
    v_mfma_f32_16x16x32_bf16 a[16:19], v[48:51], v[64:67], a[16:19]
    ds_read_b64_tr_b16 v[32:33], v4 offset:256
    v_add_f32 v20, v20, v96
    v_mfma_f32_16x16x32_bf16 a[20:23], v[52:55], v[64:67], a[20:23]
    ds_read_b64_tr_b16 v[34:35], v4 offset:8448
    v_fma_f32 v104, v104, s28, v17
    v_mfma_f32_16x16x32_bf16 a[24:27], v[56:59], v[64:67], a[24:27]
    ds_read_b64_tr_b16 v[36:37], v5 offset:256
    v_fma_f32 v105, v105, s28, v17
    v_mfma_f32_16x16x32_bf16 a[28:31], v[60:63], v[64:67], a[28:31]
    ds_read_b64_tr_b16 v[38:39], v5 offset:8448
    v_fma_f32 v112, v112, s28, v18
    v_mfma_f32_16x16x32_bf16 a[80:83], v[48:51], v[72:75], a[80:83]
    ds_read_b64_tr_b16 v[40:41], v6 offset:256
    v_fma_f32 v113, v113, s28, v18
    v_mfma_f32_16x16x32_bf16 a[84:87], v[52:55], v[72:75], a[84:87]
    ds_read_b64_tr_b16 v[42:43], v6 offset:8448
    v_fma_f32 v120, v120, s28, v19
    v_mfma_f32_16x16x32_bf16 a[88:91], v[56:59], v[72:75], a[88:91]
    ds_read_b64_tr_b16 v[44:45], v7 offset:256
    v_fma_f32 v121, v121, s28, v19
    v_mfma_f32_16x16x32_bf16 a[92:95], v[60:63], v[72:75], a[92:95]
    ds_read_b64_tr_b16 v[46:47], v7 offset:8448
    v_fma_f32 v98, v98, s28, v16
    v_mfma_f32_16x16x32_bf16 a[144:147], v[48:51], v[80:83], a[144:147]
    v_exp_f32 v97, v97
    v_mfma_f32_16x16x32_bf16 a[148:151], v[52:55], v[80:83], a[148:151]
    v_cvt_pk_bf16_f32 v96, v96, v97
    v_mfma_f32_16x16x32_bf16 a[152:155], v[56:59], v[80:83], a[152:155]
    v_exp_f32 v104, v104
    v_mfma_f32_16x16x32_bf16 a[156:159], v[60:63], v[80:83], a[156:159]
    v_xor_b32 v14, 64, v13
    v_add_f32 v20, v20, v97
    v_mfma_f32_16x16x32_bf16 a[208:211], v[48:51], v[88:91], a[208:211]
    buffer_load_dwordx4 v14, s[20:23], s31 offen offset:1024 lds
    v_mfma_f32_16x16x32_bf16 a[212:215], v[52:55], v[88:91], a[212:215]
    v_exp_f32 v105, v105
    v_mfma_f32_16x16x32_bf16 a[216:219], v[56:59], v[88:91], a[216:219]
    v_exp_f32 v112, v112
    v_mfma_f32_16x16x32_bf16 a[220:223], v[60:63], v[88:91], a[220:223]
    v_exp_f32 v113, v113
    s_waitcnt lgkmcnt(0)
    v_mfma_f32_16x16x32_bf16 a[32:35], v[32:35], v[64:67], a[32:35]
    ds_read_b64_tr_b16 v[48:49], v8 offset:256
    v_add_f32 v21, v21, v104
    v_mfma_f32_16x16x32_bf16 a[36:39], v[36:39], v[64:67], a[36:39]
    ds_read_b64_tr_b16 v[50:51], v8 offset:8448
    v_cvt_pk_bf16_f32 v104, v104, v105
    v_mfma_f32_16x16x32_bf16 a[40:43], v[40:43], v[64:67], a[40:43]
    ds_read_b64_tr_b16 v[52:53], v9 offset:256
    v_add_f32 v21, v21, v105
    v_mfma_f32_16x16x32_bf16 a[44:47], v[44:47], v[64:67], a[44:47]
    ds_read_b64_tr_b16 v[54:55], v9 offset:8448
    v_add_f32 v22, v22, v112
    v_mfma_f32_16x16x32_bf16 a[96:99], v[32:35], v[72:75], a[96:99]
    ds_read_b64_tr_b16 v[56:57], v10 offset:256
    v_mfma_f32_16x16x32_bf16 a[100:103], v[36:39], v[72:75], a[100:103]
    ds_read_b64_tr_b16 v[58:59], v10 offset:8448
    v_cvt_pk_bf16_f32 v112, v112, v113
    v_mfma_f32_16x16x32_bf16 a[104:107], v[40:43], v[72:75], a[104:107]
    ds_read_b64_tr_b16 v[60:61], v11 offset:256
    v_add_f32 v22, v22, v113
    v_mfma_f32_16x16x32_bf16 a[108:111], v[44:47], v[72:75], a[108:111]
    ds_read_b64_tr_b16 v[62:63], v11 offset:8448
    v_fma_f32 v99, v99, s28, v16
    v_mfma_f32_16x16x32_bf16 a[160:163], v[32:35], v[80:83], a[160:163]
    v_xor_b32 v14, 128, v13
    v_fma_f32 v106, v106, s28, v17
    v_mfma_f32_16x16x32_bf16 a[164:167], v[36:39], v[80:83], a[164:167]
    buffer_load_dwordx4 v14, s[20:23], s31 offen offset:2048 lds
    v_mfma_f32_16x16x32_bf16 a[168:171], v[40:43], v[80:83], a[168:171]
    v_exp_f32 v120, v120
    v_mfma_f32_16x16x32_bf16 a[172:175], v[44:47], v[80:83], a[172:175]
    v_exp_f32 v121, v121
    v_mfma_f32_16x16x32_bf16 a[224:227], v[32:35], v[88:91], a[224:227]
    v_exp_f32 v98, v98
    v_mfma_f32_16x16x32_bf16 a[228:231], v[36:39], v[88:91], a[228:231]
    v_exp_f32 v99, v99
    v_mfma_f32_16x16x32_bf16 a[232:235], v[40:43], v[88:91], a[232:235]
    v_exp_f32 v106, v106
    v_mfma_f32_16x16x32_bf16 a[236:239], v[44:47], v[88:91], a[236:239]
    v_add_f32 v23, v23, v120
    v_cvt_pk_bf16_f32 v120, v120, v121
    s_waitcnt lgkmcnt(0)
    v_mfma_f32_16x16x32_bf16 a[48:51], v[48:51], v[64:67], a[48:51]
    ds_read_b128 v[32:35], v0 offset:32768
    v_add_f32 v23, v23, v121
    v_mfma_f32_16x16x32_bf16 a[52:55], v[52:55], v[64:67], a[52:55]
    ds_read_b128 v[36:39], v1 offset:32768
    v_add_f32 v20, v20, v98
    v_mfma_f32_16x16x32_bf16 a[56:59], v[56:59], v[64:67], a[56:59]
    ds_read_b128 v[40:43], v2 offset:32768
    v_cvt_pk_bf16_f32 v97, v98, v99
    v_mfma_f32_16x16x32_bf16 a[60:63], v[60:63], v[64:67], a[60:63]
    ds_read_b128 v[44:47], v3 offset:32768
    v_add_f32 v20, v20, v99
    v_mfma_f32_16x16x32_bf16 a[112:115], v[48:51], v[72:75], a[112:115]
    v_fma_f32 v107, v107, s28, v17
    v_add_f32 v21, v21, v106
    v_mfma_f32_16x16x32_bf16 a[116:119], v[52:55], v[72:75], a[116:119]
    v_xor_b32 v14, 192, v13
    v_fma_f32 v114, v114, s28, v18
    v_mfma_f32_16x16x32_bf16 a[120:123], v[56:59], v[72:75], a[120:123]
    buffer_load_dwordx4 v14, s[20:23], s31 offen offset:3072 lds
    s_add_u32 s31, s31, 16384
    v_mfma_f32_16x16x32_bf16 a[124:127], v[60:63], v[72:75], a[124:127]
    v_exp_f32 v107, v107
    v_mfma_f32_16x16x32_bf16 a[176:179], v[48:51], v[80:83], a[176:179]
    v_exp_f32 v114, v114
    v_mfma_f32_16x16x32_bf16 a[180:183], v[52:55], v[80:83], a[180:183]
    v_cvt_pk_bf16_f32 v105, v106, v107
    v_add_f32 v21, v21, v107
    v_mfma_f32_16x16x32_bf16 a[184:187], v[56:59], v[80:83], a[184:187]
    v_fma_f32 v115, v115, s28, v18
    v_add_f32 v22, v22, v114
    v_mfma_f32_16x16x32_bf16 a[188:191], v[60:63], v[80:83], a[188:191]
    v_exp_f32 v115, v115
    v_mfma_f32_16x16x32_bf16 a[240:243], v[48:51], v[88:91], a[240:243]
    v_cvt_pk_bf16_f32 v113, v114, v115
    v_add_f32 v22, v22, v115
    v_mfma_f32_16x16x32_bf16 a[244:247], v[52:55], v[88:91], a[244:247]
    v_fma_f32 v122, v122, s28, v19
    v_fma_f32 v123, v123, s28, v19
    v_mfma_f32_16x16x32_bf16 a[248:251], v[56:59], v[88:91], a[248:251]
    v_exp_f32 v122, v122
    v_mfma_f32_16x16x32_bf16 a[252:255], v[60:63], v[88:91], a[252:255]
    v_exp_f32 v123, v123
    s_cmp_eq_u32 s33, 0
    s_cbranch_scc0 L_skipB_0_stub
L_skipB_0:
    s_waitcnt lgkmcnt(0)
    v_mfma_f32_16x16x32_bf16 v[64:67], v[32:35], v[128:131], 0
    ds_read_b128 v[48:51], v0 offset:33024
    v_add_f32 v23, v23, v122
    v_mfma_f32_16x16x32_bf16 v[64:67], v[36:39], v[132:135], v[64:67]
    ds_read_b128 v[52:55], v1 offset:33024
    v_cvt_pk_bf16_f32 v121, v122, v123
    v_mfma_f32_16x16x32_bf16 v[64:67], v[40:43], v[136:139], v[64:67]
    ds_read_b128 v[56:59], v2 offset:33024
    v_add_f32 v23, v23, v123
    v_mfma_f32_16x16x32_bf16 v[64:67], v[44:47], v[140:143], v[64:67]
    ds_read_b128 v[60:63], v3 offset:33024
    v_fma_f32 v100, v100, s28, v16
    v_mfma_f32_16x16x32_bf16 v[72:75], v[32:35], v[160:163], 0
    v_exp_f32 v100, v100
    v_mfma_f32_16x16x32_bf16 v[72:75], v[36:39], v[164:167], v[72:75]
    s_add_u32 m0, s29, 16384
    s_nop 0
    buffer_load_dwordx4 v12, s[16:19], s30 offen offset:0 lds
    v_mfma_f32_16x16x32_bf16 v[72:75], v[40:43], v[168:171], v[72:75]
    v_fma_f32 v101, v101, s28, v16
    v_add_f32 v20, v20, v100
    v_mfma_f32_16x16x32_bf16 v[72:75], v[44:47], v[172:175], v[72:75]
    v_exp_f32 v101, v101
    v_mfma_f32_16x16x32_bf16 v[80:83], v[32:35], v[192:195], 0
    v_cvt_pk_bf16_f32 v98, v100, v101
    v_add_f32 v20, v20, v101
    v_mfma_f32_16x16x32_bf16 v[80:83], v[36:39], v[196:199], v[80:83]
    v_fma_f32 v108, v108, s28, v17
    v_fma_f32 v109, v109, s28, v17
    v_mfma_f32_16x16x32_bf16 v[80:83], v[40:43], v[200:203], v[80:83]
    v_exp_f32 v108, v108
    v_mfma_f32_16x16x32_bf16 v[80:83], v[44:47], v[204:207], v[80:83]
    v_exp_f32 v109, v109
    v_mfma_f32_16x16x32_bf16 v[88:91], v[32:35], v[224:227], 0
    v_add_f32 v21, v21, v108
    v_cvt_pk_bf16_f32 v106, v108, v109
    v_mfma_f32_16x16x32_bf16 v[88:91], v[36:39], v[228:231], v[88:91]
    v_add_f32 v21, v21, v109
    v_fma_f32 v116, v116, s28, v18
    v_mfma_f32_16x16x32_bf16 v[88:91], v[40:43], v[232:235], v[88:91]
    v_exp_f32 v116, v116
    v_mfma_f32_16x16x32_bf16 v[88:91], v[44:47], v[236:239], v[88:91]
    v_fma_f32 v117, v117, s28, v18
    v_add_f32 v22, v22, v116
    s_waitcnt lgkmcnt(0)
    v_mfma_f32_16x16x32_bf16 v[64:67], v[48:51], v[144:147], v[64:67]
    ds_read_b128 v[32:35], v0 offset:40960
    v_xor_b32 v14, 32, v12
    v_mfma_f32_16x16x32_bf16 v[64:67], v[52:55], v[148:151], v[64:67]
    ds_read_b128 v[36:39], v1 offset:40960
    v_fma_f32 v124, v124, s28, v19
    v_mfma_f32_16x16x32_bf16 v[64:67], v[56:59], v[152:155], v[64:67]
    ds_read_b128 v[40:43], v2 offset:40960
    v_fma_f32 v125, v125, s28, v19
    v_mfma_f32_16x16x32_bf16 v[64:67], v[60:63], v[156:159], v[64:67]
    ds_read_b128 v[44:47], v3 offset:40960
    v_fma_f32 v102, v102, s28, v16
    v_mfma_f32_16x16x32_bf16 v[72:75], v[48:51], v[176:179], v[72:75]
    buffer_load_dwordx4 v14, s[16:19], s30 offen offset:1024 lds
    v_mfma_f32_16x16x32_bf16 v[72:75], v[52:55], v[180:183], v[72:75]
    v_exp_f32 v117, v117
    v_mfma_f32_16x16x32_bf16 v[72:75], v[56:59], v[184:187], v[72:75]
    v_exp_f32 v124, v124
    v_mfma_f32_16x16x32_bf16 v[72:75], v[60:63], v[188:191], v[72:75]
    v_exp_f32 v125, v125
    v_mfma_f32_16x16x32_bf16 v[80:83], v[48:51], v[208:211], v[80:83]
    v_exp_f32 v102, v102
    v_mfma_f32_16x16x32_bf16 v[80:83], v[52:55], v[212:215], v[80:83]
    v_cvt_pk_bf16_f32 v114, v116, v117
    v_add_f32 v22, v22, v117
    v_mfma_f32_16x16x32_bf16 v[80:83], v[56:59], v[216:219], v[80:83]
    v_add_f32 v23, v23, v124
    v_cvt_pk_bf16_f32 v122, v124, v125
    v_mfma_f32_16x16x32_bf16 v[80:83], v[60:63], v[220:223], v[80:83]
    v_xor_b32 v14, 64, v12
    v_add_f32 v23, v23, v125
    v_mfma_f32_16x16x32_bf16 v[88:91], v[48:51], v[240:243], v[88:91]
    buffer_load_dwordx4 v14, s[16:19], s30 offen offset:2048 lds
    v_mfma_f32_16x16x32_bf16 v[88:91], v[52:55], v[244:247], v[88:91]
    v_fma_f32 v103, v103, s28, v16
    v_add_f32 v20, v20, v102
    v_mfma_f32_16x16x32_bf16 v[88:91], v[56:59], v[248:251], v[88:91]
    v_exp_f32 v103, v103
    v_mfma_f32_16x16x32_bf16 v[88:91], v[60:63], v[252:255], v[88:91]
    v_cvt_pk_bf16_f32 v99, v102, v103
    v_add_f32 v20, v20, v103
    s_waitcnt lgkmcnt(0)
    v_mfma_f32_16x16x32_bf16 v[68:71], v[32:35], v[128:131], 0
    ds_read_b128 v[48:51], v0 offset:41216
    v_fma_f32 v110, v110, s28, v17
    v_mfma_f32_16x16x32_bf16 v[68:71], v[36:39], v[132:135], v[68:71]
    ds_read_b128 v[52:55], v1 offset:41216
    v_fma_f32 v111, v111, s28, v17
    v_mfma_f32_16x16x32_bf16 v[68:71], v[40:43], v[136:139], v[68:71]
    ds_read_b128 v[56:59], v2 offset:41216
    v_fma_f32 v118, v118, s28, v18
    v_mfma_f32_16x16x32_bf16 v[68:71], v[44:47], v[140:143], v[68:71]
    ds_read_b128 v[60:63], v3 offset:41216
    v_fma_f32 v119, v119, s28, v18
    v_mfma_f32_16x16x32_bf16 v[76:79], v[32:35], v[160:163], 0
    v_exp_f32 v110, v110
    v_mfma_f32_16x16x32_bf16 v[76:79], v[36:39], v[164:167], v[76:79]
    v_exp_f32 v111, v111
    v_mfma_f32_16x16x32_bf16 v[76:79], v[40:43], v[168:171], v[76:79]
    v_xor_b32 v14, 96, v12
    v_add_f32 v21, v21, v110
    v_mfma_f32_16x16x32_bf16 v[76:79], v[44:47], v[172:175], v[76:79]
    buffer_load_dwordx4 v14, s[16:19], s30 offen offset:3072 lds
    s_add_u32 s30, s30, 16384
    v_mfma_f32_16x16x32_bf16 v[84:87], v[32:35], v[192:195], 0
    v_exp_f32 v118, v118
    v_mfma_f32_16x16x32_bf16 v[84:87], v[36:39], v[196:199], v[84:87]
    v_exp_f32 v119, v119
    v_mfma_f32_16x16x32_bf16 v[84:87], v[40:43], v[200:203], v[84:87]
    v_cvt_pk_bf16_f32 v107, v110, v111
    v_add_f32 v21, v21, v111
    v_mfma_f32_16x16x32_bf16 v[84:87], v[44:47], v[204:207], v[84:87]
    v_add_f32 v22, v22, v118
    v_cvt_pk_bf16_f32 v115, v118, v119
    v_mfma_f32_16x16x32_bf16 v[92:95], v[32:35], v[224:227], 0
    v_add_f32 v22, v22, v119
    v_fma_f32 v126, v126, s28, v19
    v_mfma_f32_16x16x32_bf16 v[92:95], v[36:39], v[228:231], v[92:95]
    v_exp_f32 v126, v126
    v_mfma_f32_16x16x32_bf16 v[92:95], v[40:43], v[232:235], v[92:95]
    v_fma_f32 v127, v127, s28, v19
    v_add_f32 v23, v23, v126
    v_mfma_f32_16x16x32_bf16 v[92:95], v[44:47], v[236:239], v[92:95]
    v_exp_f32 v127, v127
    s_waitcnt lgkmcnt(0)
    v_mfma_f32_16x16x32_bf16 v[68:71], v[48:51], v[144:147], v[68:71]
    ds_read_b64_tr_b16 v[32:33], v4 offset:16384
    v_cvt_pk_bf16_f32 v123, v126, v127
    v_mfma_f32_16x16x32_bf16 v[68:71], v[52:55], v[148:151], v[68:71]
    ds_read_b64_tr_b16 v[34:35], v4 offset:24576
    v_add_f32 v23, v23, v127
    v_mfma_f32_16x16x32_bf16 v[68:71], v[56:59], v[152:155], v[68:71]
    ds_read_b64_tr_b16 v[36:37], v5 offset:16384
    v_max3_f32 v24, v64, v65, v66
    s_waitcnt vmcnt(12)
    s_barrier
    v_mfma_f32_16x16x32_bf16 v[68:71], v[60:63], v[156:159], v[68:71]
    ds_read_b64_tr_b16 v[38:39], v5 offset:24576
    v_max3_f32 v25, v72, v73, v74
    v_mfma_f32_16x16x32_bf16 v[76:79], v[48:51], v[176:179], v[76:79]
    ds_read_b64_tr_b16 v[40:41], v6 offset:16384
    v_max3_f32 v26, v80, v81, v82
    v_mfma_f32_16x16x32_bf16 v[76:79], v[52:55], v[180:183], v[76:79]
    ds_read_b64_tr_b16 v[42:43], v6 offset:24576
    v_max3_f32 v27, v88, v89, v90
    v_mfma_f32_16x16x32_bf16 v[76:79], v[56:59], v[184:187], v[76:79]
    ds_read_b64_tr_b16 v[44:45], v7 offset:16384
    v_max_f32 v24, v24, v67
    v_mfma_f32_16x16x32_bf16 v[76:79], v[60:63], v[188:191], v[76:79]
    ds_read_b64_tr_b16 v[46:47], v7 offset:24576
    v_max_f32 v25, v25, v75
    v_mfma_f32_16x16x32_bf16 v[84:87], v[48:51], v[208:211], v[84:87]
    v_max_f32 v26, v26, v83
    v_max_f32 v27, v27, v91
    v_mfma_f32_16x16x32_bf16 v[84:87], v[52:55], v[212:215], v[84:87]
    v_mfma_f32_16x16x32_bf16 v[84:87], v[56:59], v[216:219], v[84:87]
    v_mfma_f32_16x16x32_bf16 v[84:87], v[60:63], v[220:223], v[84:87]
    v_mfma_f32_16x16x32_bf16 v[92:95], v[48:51], v[240:243], v[92:95]
    v_mfma_f32_16x16x32_bf16 v[92:95], v[52:55], v[244:247], v[92:95]
    v_mfma_f32_16x16x32_bf16 v[92:95], v[56:59], v[248:251], v[92:95]
    v_mfma_f32_16x16x32_bf16 v[92:95], v[60:63], v[252:255], v[92:95]
    s_waitcnt lgkmcnt(0)
    v_mfma_f32_16x16x32_bf16 a[0:3], v[32:35], v[96:99], a[0:3]
    ds_read_b64_tr_b16 v[48:49], v8 offset:16384
    v_mfma_f32_16x16x32_bf16 a[4:7], v[36:39], v[96:99], a[4:7]
    ds_read_b64_tr_b16 v[50:51], v8 offset:24576
    v_mfma_f32_16x16x32_bf16 a[8:11], v[40:43], v[96:99], a[8:11]
    ds_read_b64_tr_b16 v[52:53], v9 offset:16384
    v_max3_f32 v24, v24, v68, v69
    v_mfma_f32_16x16x32_bf16 a[12:15], v[44:47], v[96:99], a[12:15]
    ds_read_b64_tr_b16 v[54:55], v9 offset:24576
    v_max3_f32 v25, v25, v76, v77
    v_mfma_f32_16x16x32_bf16 a[64:67], v[32:35], v[104:107], a[64:67]
    ds_read_b64_tr_b16 v[56:57], v10 offset:16384
    v_max3_f32 v26, v26, v84, v85
    v_mfma_f32_16x16x32_bf16 a[68:71], v[36:39], v[104:107], a[68:71]
    ds_read_b64_tr_b16 v[58:59], v10 offset:24576
    v_max3_f32 v27, v27, v92, v93
    v_mfma_f32_16x16x32_bf16 a[72:75], v[40:43], v[104:107], a[72:75]
    ds_read_b64_tr_b16 v[60:61], v11 offset:16384
    v_max3_f32 v24, v24, v70, v71
    v_mfma_f32_16x16x32_bf16 a[76:79], v[44:47], v[104:107], a[76:79]
    ds_read_b64_tr_b16 v[62:63], v11 offset:24576
    v_max3_f32 v25, v25, v78, v79
    v_mfma_f32_16x16x32_bf16 a[128:131], v[32:35], v[112:115], a[128:131]
    v_max3_f32 v26, v26, v86, v87
    v_max3_f32 v27, v27, v94, v95
    v_mfma_f32_16x16x32_bf16 a[132:135], v[36:39], v[112:115], a[132:135]
    v_fma_f32 v28, v24, s28, v16
    v_fma_f32 v29, v25, s28, v17
    v_mfma_f32_16x16x32_bf16 a[136:139], v[40:43], v[112:115], a[136:139]
    v_fma_f32 v30, v26, s28, v18
    v_fma_f32 v31, v27, s28, v19
    v_mfma_f32_16x16x32_bf16 a[140:143], v[44:47], v[112:115], a[140:143]
    v_max3_f32 v28, v28, v29, v30
    v_max_f32 v28, v28, v31
    v_mfma_f32_16x16x32_bf16 a[192:195], v[32:35], v[120:123], a[192:195]
    v_cmp_lt_f32 vcc, 0x41000000, v28
    s_cbranch_vccnz L_skipA_1_stub
L_skipA_1:
    v_mfma_f32_16x16x32_bf16 a[196:199], v[36:39], v[120:123], a[196:199]
    v_fma_f32 v64, v64, s28, v16
    v_fma_f32 v65, v65, s28, v16
    v_mfma_f32_16x16x32_bf16 a[200:203], v[40:43], v[120:123], a[200:203]
    s_add_u32 m0, s29, 65536
    s_nop 0
    buffer_load_dwordx4 v13, s[20:23], s31 offen offset:0 lds
    v_mfma_f32_16x16x32_bf16 a[204:207], v[44:47], v[120:123], a[204:207]
    v_exp_f32 v64, v64
    s_waitcnt lgkmcnt(0)
    v_mfma_f32_16x16x32_bf16 a[16:19], v[48:51], v[96:99], a[16:19]
    ds_read_b64_tr_b16 v[32:33], v4 offset:16640
    v_add_f32 v20, v20, v64
    v_mfma_f32_16x16x32_bf16 a[20:23], v[52:55], v[96:99], a[20:23]
    ds_read_b64_tr_b16 v[34:35], v4 offset:24832
    v_fma_f32 v72, v72, s28, v17
    v_mfma_f32_16x16x32_bf16 a[24:27], v[56:59], v[96:99], a[24:27]
    ds_read_b64_tr_b16 v[36:37], v5 offset:16640
    v_fma_f32 v73, v73, s28, v17
    v_mfma_f32_16x16x32_bf16 a[28:31], v[60:63], v[96:99], a[28:31]
    ds_read_b64_tr_b16 v[38:39], v5 offset:24832
    v_fma_f32 v80, v80, s28, v18
    v_mfma_f32_16x16x32_bf16 a[80:83], v[48:51], v[104:107], a[80:83]
    ds_read_b64_tr_b16 v[40:41], v6 offset:16640
    v_fma_f32 v81, v81, s28, v18
    v_mfma_f32_16x16x32_bf16 a[84:87], v[52:55], v[104:107], a[84:87]
    ds_read_b64_tr_b16 v[42:43], v6 offset:24832
    v_fma_f32 v88, v88, s28, v19
    v_mfma_f32_16x16x32_bf16 a[88:91], v[56:59], v[104:107], a[88:91]
    ds_read_b64_tr_b16 v[44:45], v7 offset:16640
    v_fma_f32 v89, v89, s28, v19
    v_mfma_f32_16x16x32_bf16 a[92:95], v[60:63], v[104:107], a[92:95]
    ds_read_b64_tr_b16 v[46:47], v7 offset:24832
    v_fma_f32 v66, v66, s28, v16
    v_mfma_f32_16x16x32_bf16 a[144:147], v[48:51], v[112:115], a[144:147]
    v_exp_f32 v65, v65
    v_mfma_f32_16x16x32_bf16 a[148:151], v[52:55], v[112:115], a[148:151]
    v_cvt_pk_bf16_f32 v64, v64, v65
    v_mfma_f32_16x16x32_bf16 a[152:155], v[56:59], v[112:115], a[152:155]
    v_exp_f32 v72, v72
    v_mfma_f32_16x16x32_bf16 a[156:159], v[60:63], v[112:115], a[156:159]
    v_xor_b32 v14, 64, v13
    v_add_f32 v20, v20, v65
    v_mfma_f32_16x16x32_bf16 a[208:211], v[48:51], v[120:123], a[208:211]
    buffer_load_dwordx4 v14, s[20:23], s31 offen offset:1024 lds
    v_mfma_f32_16x16x32_bf16 a[212:215], v[52:55], v[120:123], a[212:215]
    v_exp_f32 v73, v73
    v_mfma_f32_16x16x32_bf16 a[216:219], v[56:59], v[120:123], a[216:219]
    v_exp_f32 v80, v80
    v_mfma_f32_16x16x32_bf16 a[220:223], v[60:63], v[120:123], a[220:223]
    v_exp_f32 v81, v81
    s_waitcnt lgkmcnt(0)
    v_mfma_f32_16x16x32_bf16 a[32:35], v[32:35], v[96:99], a[32:35]
    ds_read_b64_tr_b16 v[48:49], v8 offset:16640
    v_add_f32 v21, v21, v72
    v_mfma_f32_16x16x32_bf16 a[36:39], v[36:39], v[96:99], a[36:39]
    ds_read_b64_tr_b16 v[50:51], v8 offset:24832
    v_cvt_pk_bf16_f32 v72, v72, v73
    v_mfma_f32_16x16x32_bf16 a[40:43], v[40:43], v[96:99], a[40:43]
    ds_read_b64_tr_b16 v[52:53], v9 offset:16640
    v_add_f32 v21, v21, v73
    v_mfma_f32_16x16x32_bf16 a[44:47], v[44:47], v[96:99], a[44:47]
    ds_read_b64_tr_b16 v[54:55], v9 offset:24832
    v_add_f32 v22, v22, v80
    v_mfma_f32_16x16x32_bf16 a[96:99], v[32:35], v[104:107], a[96:99]
    ds_read_b64_tr_b16 v[56:57], v10 offset:16640
    v_mfma_f32_16x16x32_bf16 a[100:103], v[36:39], v[104:107], a[100:103]
    ds_read_b64_tr_b16 v[58:59], v10 offset:24832
    v_cvt_pk_bf16_f32 v80, v80, v81
    v_mfma_f32_16x16x32_bf16 a[104:107], v[40:43], v[104:107], a[104:107]
    ds_read_b64_tr_b16 v[60:61], v11 offset:16640
    v_add_f32 v22, v22, v81
    v_mfma_f32_16x16x32_bf16 a[108:111], v[44:47], v[104:107], a[108:111]
    ds_read_b64_tr_b16 v[62:63], v11 offset:24832
    v_fma_f32 v67, v67, s28, v16
    v_mfma_f32_16x16x32_bf16 a[160:163], v[32:35], v[112:115], a[160:163]
    v_xor_b32 v14, 128, v13
    v_fma_f32 v74, v74, s28, v17
    v_mfma_f32_16x16x32_bf16 a[164:167], v[36:39], v[112:115], a[164:167]
    buffer_load_dwordx4 v14, s[20:23], s31 offen offset:2048 lds
    v_mfma_f32_16x16x32_bf16 a[168:171], v[40:43], v[112:115], a[168:171]
    v_exp_f32 v88, v88
    v_mfma_f32_16x16x32_bf16 a[172:175], v[44:47], v[112:115], a[172:175]
    v_exp_f32 v89, v89
    v_mfma_f32_16x16x32_bf16 a[224:227], v[32:35], v[120:123], a[224:227]
    v_exp_f32 v66, v66
    v_mfma_f32_16x16x32_bf16 a[228:231], v[36:39], v[120:123], a[228:231]
    v_exp_f32 v67, v67
    v_mfma_f32_16x16x32_bf16 a[232:235], v[40:43], v[120:123], a[232:235]
    v_exp_f32 v74, v74
    v_mfma_f32_16x16x32_bf16 a[236:239], v[44:47], v[120:123], a[236:239]
    v_add_f32 v23, v23, v88
    v_cvt_pk_bf16_f32 v88, v88, v89
    s_waitcnt lgkmcnt(0)
    v_mfma_f32_16x16x32_bf16 a[48:51], v[48:51], v[96:99], a[48:51]
    ds_read_b128 v[32:35], v0 offset:49152
    v_add_f32 v23, v23, v89
    v_mfma_f32_16x16x32_bf16 a[52:55], v[52:55], v[96:99], a[52:55]
    ds_read_b128 v[36:39], v1 offset:49152
    v_add_f32 v20, v20, v66
    v_mfma_f32_16x16x32_bf16 a[56:59], v[56:59], v[96:99], a[56:59]
    ds_read_b128 v[40:43], v2 offset:49152
    v_cvt_pk_bf16_f32 v65, v66, v67
    v_mfma_f32_16x16x32_bf16 a[60:63], v[60:63], v[96:99], a[60:63]
    ds_read_b128 v[44:47], v3 offset:49152
    v_add_f32 v20, v20, v67
    v_mfma_f32_16x16x32_bf16 a[112:115], v[48:51], v[104:107], a[112:115]
    v_fma_f32 v75, v75, s28, v17
    v_add_f32 v21, v21, v74
    v_mfma_f32_16x16x32_bf16 a[116:119], v[52:55], v[104:107], a[116:119]
    v_xor_b32 v14, 192, v13
    v_fma_f32 v82, v82, s28, v18
    v_mfma_f32_16x16x32_bf16 a[120:123], v[56:59], v[104:107], a[120:123]
    buffer_load_dwordx4 v14, s[20:23], s31 offen offset:3072 lds
    s_add_u32 s31, s31, 16384
    v_mfma_f32_16x16x32_bf16 a[124:127], v[60:63], v[104:107], a[124:127]
    v_exp_f32 v75, v75
    v_mfma_f32_16x16x32_bf16 a[176:179], v[48:51], v[112:115], a[176:179]
    v_exp_f32 v82, v82
    v_mfma_f32_16x16x32_bf16 a[180:183], v[52:55], v[112:115], a[180:183]
    v_cvt_pk_bf16_f32 v73, v74, v75
    v_add_f32 v21, v21, v75
    v_mfma_f32_16x16x32_bf16 a[184:187], v[56:59], v[112:115], a[184:187]
    v_fma_f32 v83, v83, s28, v18
    v_add_f32 v22, v22, v82
    v_mfma_f32_16x16x32_bf16 a[188:191], v[60:63], v[112:115], a[188:191]
    v_exp_f32 v83, v83
    v_mfma_f32_16x16x32_bf16 a[240:243], v[48:51], v[120:123], a[240:243]
    v_cvt_pk_bf16_f32 v81, v82, v83
    v_add_f32 v22, v22, v83
    v_mfma_f32_16x16x32_bf16 a[244:247], v[52:55], v[120:123], a[244:247]
    v_fma_f32 v90, v90, s28, v19
    v_fma_f32 v91, v91, s28, v19
    v_mfma_f32_16x16x32_bf16 a[248:251], v[56:59], v[120:123], a[248:251]
    v_exp_f32 v90, v90
    v_mfma_f32_16x16x32_bf16 a[252:255], v[60:63], v[120:123], a[252:255]
    v_exp_f32 v91, v91
    s_cmp_eq_u32 s33, 0
    s_cbranch_scc0 L_skipB_1_stub
L_skipB_1:
    s_waitcnt lgkmcnt(0)
    v_mfma_f32_16x16x32_bf16 v[96:99], v[32:35], v[128:131], 0
    ds_read_b128 v[48:51], v0 offset:49408
    v_add_f32 v23, v23, v90
    v_mfma_f32_16x16x32_bf16 v[96:99], v[36:39], v[132:135], v[96:99]
    ds_read_b128 v[52:55], v1 offset:49408
    v_cvt_pk_bf16_f32 v89, v90, v91
    v_mfma_f32_16x16x32_bf16 v[96:99], v[40:43], v[136:139], v[96:99]
    ds_read_b128 v[56:59], v2 offset:49408
    v_add_f32 v23, v23, v91
    v_mfma_f32_16x16x32_bf16 v[96:99], v[44:47], v[140:143], v[96:99]
    ds_read_b128 v[60:63], v3 offset:49408
    v_fma_f32 v68, v68, s28, v16
    v_mfma_f32_16x16x32_bf16 v[104:107], v[32:35], v[160:163], 0
    v_exp_f32 v68, v68
    v_mfma_f32_16x16x32_bf16 v[104:107], v[36:39], v[164:167], v[104:107]
    s_add_u32 m0, s29, 32768
    s_nop 0
    buffer_load_dwordx4 v12, s[16:19], s30 offen offset:0 lds
    v_mfma_f32_16x16x32_bf16 v[104:107], v[40:43], v[168:171], v[104:107]
    v_fma_f32 v69, v69, s28, v16
    v_add_f32 v20, v20, v68
    v_mfma_f32_16x16x32_bf16 v[104:107], v[44:47], v[172:175], v[104:107]
    v_exp_f32 v69, v69
    v_mfma_f32_16x16x32_bf16 v[112:115], v[32:35], v[192:195], 0
    v_cvt_pk_bf16_f32 v66, v68, v69
    v_add_f32 v20, v20, v69
    v_mfma_f32_16x16x32_bf16 v[112:115], v[36:39], v[196:199], v[112:115]
    v_fma_f32 v76, v76, s28, v17
    v_fma_f32 v77, v77, s28, v17
    v_mfma_f32_16x16x32_bf16 v[112:115], v[40:43], v[200:203], v[112:115]
    v_exp_f32 v76, v76
    v_mfma_f32_16x16x32_bf16 v[112:115], v[44:47], v[204:207], v[112:115]
    v_exp_f32 v77, v77
    v_mfma_f32_16x16x32_bf16 v[120:123], v[32:35], v[224:227], 0
    v_add_f32 v21, v21, v76
    v_cvt_pk_bf16_f32 v74, v76, v77
    v_mfma_f32_16x16x32_bf16 v[120:123], v[36:39], v[228:231], v[120:123]
    v_add_f32 v21, v21, v77
    v_fma_f32 v84, v84, s28, v18
    v_mfma_f32_16x16x32_bf16 v[120:123], v[40:43], v[232:235], v[120:123]
    v_exp_f32 v84, v84
    v_mfma_f32_16x16x32_bf16 v[120:123], v[44:47], v[236:239], v[120:123]
    v_fma_f32 v85, v85, s28, v18
    v_add_f32 v22, v22, v84
    s_waitcnt lgkmcnt(0)
    v_mfma_f32_16x16x32_bf16 v[96:99], v[48:51], v[144:147], v[96:99]
    ds_read_b128 v[32:35], v0 offset:57344
    v_xor_b32 v14, 32, v12
    v_mfma_f32_16x16x32_bf16 v[96:99], v[52:55], v[148:151], v[96:99]
    ds_read_b128 v[36:39], v1 offset:57344
    v_fma_f32 v92, v92, s28, v19
    v_mfma_f32_16x16x32_bf16 v[96:99], v[56:59], v[152:155], v[96:99]
    ds_read_b128 v[40:43], v2 offset:57344
    v_fma_f32 v93, v93, s28, v19
    v_mfma_f32_16x16x32_bf16 v[96:99], v[60:63], v[156:159], v[96:99]
    ds_read_b128 v[44:47], v3 offset:57344
    v_fma_f32 v70, v70, s28, v16
    v_mfma_f32_16x16x32_bf16 v[104:107], v[48:51], v[176:179], v[104:107]
    buffer_load_dwordx4 v14, s[16:19], s30 offen offset:1024 lds
    v_mfma_f32_16x16x32_bf16 v[104:107], v[52:55], v[180:183], v[104:107]
    v_exp_f32 v85, v85
    v_mfma_f32_16x16x32_bf16 v[104:107], v[56:59], v[184:187], v[104:107]
    v_exp_f32 v92, v92
    v_mfma_f32_16x16x32_bf16 v[104:107], v[60:63], v[188:191], v[104:107]
    v_exp_f32 v93, v93
    v_mfma_f32_16x16x32_bf16 v[112:115], v[48:51], v[208:211], v[112:115]
    v_exp_f32 v70, v70
    v_mfma_f32_16x16x32_bf16 v[112:115], v[52:55], v[212:215], v[112:115]
    v_cvt_pk_bf16_f32 v82, v84, v85
    v_add_f32 v22, v22, v85
    v_mfma_f32_16x16x32_bf16 v[112:115], v[56:59], v[216:219], v[112:115]
    v_add_f32 v23, v23, v92
    v_cvt_pk_bf16_f32 v90, v92, v93
    v_mfma_f32_16x16x32_bf16 v[112:115], v[60:63], v[220:223], v[112:115]
    v_xor_b32 v14, 64, v12
    v_add_f32 v23, v23, v93
    v_mfma_f32_16x16x32_bf16 v[120:123], v[48:51], v[240:243], v[120:123]
    buffer_load_dwordx4 v14, s[16:19], s30 offen offset:2048 lds
    v_mfma_f32_16x16x32_bf16 v[120:123], v[52:55], v[244:247], v[120:123]
    v_fma_f32 v71, v71, s28, v16
    v_add_f32 v20, v20, v70
    v_mfma_f32_16x16x32_bf16 v[120:123], v[56:59], v[248:251], v[120:123]
    v_exp_f32 v71, v71
    v_mfma_f32_16x16x32_bf16 v[120:123], v[60:63], v[252:255], v[120:123]
    v_cvt_pk_bf16_f32 v67, v70, v71
    v_add_f32 v20, v20, v71
    s_waitcnt lgkmcnt(0)
    v_mfma_f32_16x16x32_bf16 v[100:103], v[32:35], v[128:131], 0
    ds_read_b128 v[48:51], v0 offset:57600
    v_fma_f32 v78, v78, s28, v17
    v_mfma_f32_16x16x32_bf16 v[100:103], v[36:39], v[132:135], v[100:103]
    ds_read_b128 v[52:55], v1 offset:57600
    v_fma_f32 v79, v79, s28, v17
    v_mfma_f32_16x16x32_bf16 v[100:103], v[40:43], v[136:139], v[100:103]
    ds_read_b128 v[56:59], v2 offset:57600
    v_fma_f32 v86, v86, s28, v18
    v_mfma_f32_16x16x32_bf16 v[100:103], v[44:47], v[140:143], v[100:103]
    ds_read_b128 v[60:63], v3 offset:57600
    v_fma_f32 v87, v87, s28, v18
    v_mfma_f32_16x16x32_bf16 v[108:111], v[32:35], v[160:163], 0
    v_exp_f32 v78, v78
    v_mfma_f32_16x16x32_bf16 v[108:111], v[36:39], v[164:167], v[108:111]
    v_exp_f32 v79, v79
    v_mfma_f32_16x16x32_bf16 v[108:111], v[40:43], v[168:171], v[108:111]
    v_xor_b32 v14, 96, v12
    v_add_f32 v21, v21, v78
    v_mfma_f32_16x16x32_bf16 v[108:111], v[44:47], v[172:175], v[108:111]
    buffer_load_dwordx4 v14, s[16:19], s30 offen offset:3072 lds
    s_add_u32 s30, s30, 16384
    v_mfma_f32_16x16x32_bf16 v[116:119], v[32:35], v[192:195], 0
    v_exp_f32 v86, v86
    v_mfma_f32_16x16x32_bf16 v[116:119], v[36:39], v[196:199], v[116:119]
    v_exp_f32 v87, v87
    v_mfma_f32_16x16x32_bf16 v[116:119], v[40:43], v[200:203], v[116:119]
    v_cvt_pk_bf16_f32 v75, v78, v79
    v_add_f32 v21, v21, v79
    v_mfma_f32_16x16x32_bf16 v[116:119], v[44:47], v[204:207], v[116:119]
    v_add_f32 v22, v22, v86
    v_cvt_pk_bf16_f32 v83, v86, v87
    v_mfma_f32_16x16x32_bf16 v[124:127], v[32:35], v[224:227], 0
    v_add_f32 v22, v22, v87
    v_fma_f32 v94, v94, s28, v19
    v_mfma_f32_16x16x32_bf16 v[124:127], v[36:39], v[228:231], v[124:127]
    v_exp_f32 v94, v94
    v_mfma_f32_16x16x32_bf16 v[124:127], v[40:43], v[232:235], v[124:127]
    v_fma_f32 v95, v95, s28, v19
    v_add_f32 v23, v23, v94
    v_mfma_f32_16x16x32_bf16 v[124:127], v[44:47], v[236:239], v[124:127]
    v_exp_f32 v95, v95
    s_waitcnt lgkmcnt(0)
    v_mfma_f32_16x16x32_bf16 v[100:103], v[48:51], v[144:147], v[100:103]
    ds_read_b64_tr_b16 v[32:33], v4 offset:32768
    v_cvt_pk_bf16_f32 v91, v94, v95
    v_mfma_f32_16x16x32_bf16 v[100:103], v[52:55], v[148:151], v[100:103]
    ds_read_b64_tr_b16 v[34:35], v4 offset:40960
    v_add_f32 v23, v23, v95
    v_mfma_f32_16x16x32_bf16 v[100:103], v[56:59], v[152:155], v[100:103]
    ds_read_b64_tr_b16 v[36:37], v5 offset:32768
    v_max3_f32 v24, v96, v97, v98
    s_waitcnt vmcnt(12)
    s_barrier
    v_mfma_f32_16x16x32_bf16 v[100:103], v[60:63], v[156:159], v[100:103]
    ds_read_b64_tr_b16 v[38:39], v5 offset:40960
    v_max3_f32 v25, v104, v105, v106
    v_mfma_f32_16x16x32_bf16 v[108:111], v[48:51], v[176:179], v[108:111]
    ds_read_b64_tr_b16 v[40:41], v6 offset:32768
    v_max3_f32 v26, v112, v113, v114
    v_mfma_f32_16x16x32_bf16 v[108:111], v[52:55], v[180:183], v[108:111]
    ds_read_b64_tr_b16 v[42:43], v6 offset:40960
    v_max3_f32 v27, v120, v121, v122
    v_mfma_f32_16x16x32_bf16 v[108:111], v[56:59], v[184:187], v[108:111]
    ds_read_b64_tr_b16 v[44:45], v7 offset:32768
    v_max_f32 v24, v24, v99
    v_mfma_f32_16x16x32_bf16 v[108:111], v[60:63], v[188:191], v[108:111]
    ds_read_b64_tr_b16 v[46:47], v7 offset:40960
    v_max_f32 v25, v25, v107
    v_mfma_f32_16x16x32_bf16 v[116:119], v[48:51], v[208:211], v[116:119]
    v_max_f32 v26, v26, v115
    v_max_f32 v27, v27, v123
    v_mfma_f32_16x16x32_bf16 v[116:119], v[52:55], v[212:215], v[116:119]
    v_mfma_f32_16x16x32_bf16 v[116:119], v[56:59], v[216:219], v[116:119]
    v_mfma_f32_16x16x32_bf16 v[116:119], v[60:63], v[220:223], v[116:119]
    v_mfma_f32_16x16x32_bf16 v[124:127], v[48:51], v[240:243], v[124:127]
    v_mfma_f32_16x16x32_bf16 v[124:127], v[52:55], v[244:247], v[124:127]
    v_mfma_f32_16x16x32_bf16 v[124:127], v[56:59], v[248:251], v[124:127]
    v_mfma_f32_16x16x32_bf16 v[124:127], v[60:63], v[252:255], v[124:127]
    s_waitcnt lgkmcnt(0)
    v_mfma_f32_16x16x32_bf16 a[0:3], v[32:35], v[64:67], a[0:3]
    ds_read_b64_tr_b16 v[48:49], v8 offset:32768
    v_mfma_f32_16x16x32_bf16 a[4:7], v[36:39], v[64:67], a[4:7]
    ds_read_b64_tr_b16 v[50:51], v8 offset:40960
    v_mfma_f32_16x16x32_bf16 a[8:11], v[40:43], v[64:67], a[8:11]
    ds_read_b64_tr_b16 v[52:53], v9 offset:32768
    v_max3_f32 v24, v24, v100, v101
    v_mfma_f32_16x16x32_bf16 a[12:15], v[44:47], v[64:67], a[12:15]
    ds_read_b64_tr_b16 v[54:55], v9 offset:40960
    v_max3_f32 v25, v25, v108, v109
    v_mfma_f32_16x16x32_bf16 a[64:67], v[32:35], v[72:75], a[64:67]
    ds_read_b64_tr_b16 v[56:57], v10 offset:32768
    v_max3_f32 v26, v26, v116, v117
    v_mfma_f32_16x16x32_bf16 a[68:71], v[36:39], v[72:75], a[68:71]
    ds_read_b64_tr_b16 v[58:59], v10 offset:40960
    v_max3_f32 v27, v27, v124, v125
    v_mfma_f32_16x16x32_bf16 a[72:75], v[40:43], v[72:75], a[72:75]
    ds_read_b64_tr_b16 v[60:61], v11 offset:32768
    v_max3_f32 v24, v24, v102, v103
    v_mfma_f32_16x16x32_bf16 a[76:79], v[44:47], v[72:75], a[76:79]
    ds_read_b64_tr_b16 v[62:63], v11 offset:40960
    v_max3_f32 v25, v25, v110, v111
    v_mfma_f32_16x16x32_bf16 a[128:131], v[32:35], v[80:83], a[128:131]
    v_max3_f32 v26, v26, v118, v119
    v_max3_f32 v27, v27, v126, v127
    v_mfma_f32_16x16x32_bf16 a[132:135], v[36:39], v[80:83], a[132:135]
    v_fma_f32 v28, v24, s28, v16
    v_fma_f32 v29, v25, s28, v17
    v_mfma_f32_16x16x32_bf16 a[136:139], v[40:43], v[80:83], a[136:139]
    v_fma_f32 v30, v26, s28, v18
    v_fma_f32 v31, v27, s28, v19
    v_mfma_f32_16x16x32_bf16 a[140:143], v[44:47], v[80:83], a[140:143]
    v_max3_f32 v28, v28, v29, v30
    v_max_f32 v28, v28, v31
    v_mfma_f32_16x16x32_bf16 a[192:195], v[32:35], v[88:91], a[192:195]
    v_cmp_lt_f32 vcc, 0x41000000, v28
    s_cbranch_vccnz L_skipA_2_stub
L_skipA_2:
    v_mfma_f32_16x16x32_bf16 a[196:199], v[36:39], v[88:91], a[196:199]
    v_fma_f32 v96, v96, s28, v16
    v_fma_f32 v97, v97, s28, v16
    v_mfma_f32_16x16x32_bf16 a[200:203], v[40:43], v[88:91], a[200:203]
    s_add_u32 m0, s29, 81920
    s_nop 0
    buffer_load_dwordx4 v13, s[20:23], s31 offen offset:0 lds
    v_mfma_f32_16x16x32_bf16 a[204:207], v[44:47], v[88:91], a[204:207]
    v_exp_f32 v96, v96
    s_waitcnt lgkmcnt(0)
    v_mfma_f32_16x16x32_bf16 a[16:19], v[48:51], v[64:67], a[16:19]
    ds_read_b64_tr_b16 v[32:33], v4 offset:33024
    v_add_f32 v20, v20, v96
    v_mfma_f32_16x16x32_bf16 a[20:23], v[52:55], v[64:67], a[20:23]
    ds_read_b64_tr_b16 v[34:35], v4 offset:41216
    v_fma_f32 v104, v104, s28, v17
    v_mfma_f32_16x16x32_bf16 a[24:27], v[56:59], v[64:67], a[24:27]
    ds_read_b64_tr_b16 v[36:37], v5 offset:33024
    v_fma_f32 v105, v105, s28, v17
    v_mfma_f32_16x16x32_bf16 a[28:31], v[60:63], v[64:67], a[28:31]
    ds_read_b64_tr_b16 v[38:39], v5 offset:41216
    v_fma_f32 v112, v112, s28, v18
    v_mfma_f32_16x16x32_bf16 a[80:83], v[48:51], v[72:75], a[80:83]
    ds_read_b64_tr_b16 v[40:41], v6 offset:33024
    v_fma_f32 v113, v113, s28, v18
    v_mfma_f32_16x16x32_bf16 a[84:87], v[52:55], v[72:75], a[84:87]
    ds_read_b64_tr_b16 v[42:43], v6 offset:41216
    v_fma_f32 v120, v120, s28, v19
    v_mfma_f32_16x16x32_bf16 a[88:91], v[56:59], v[72:75], a[88:91]
    ds_read_b64_tr_b16 v[44:45], v7 offset:33024
    v_fma_f32 v121, v121, s28, v19
    v_mfma_f32_16x16x32_bf16 a[92:95], v[60:63], v[72:75], a[92:95]
    ds_read_b64_tr_b16 v[46:47], v7 offset:41216
    v_fma_f32 v98, v98, s28, v16
    v_mfma_f32_16x16x32_bf16 a[144:147], v[48:51], v[80:83], a[144:147]
    v_exp_f32 v97, v97
    v_mfma_f32_16x16x32_bf16 a[148:151], v[52:55], v[80:83], a[148:151]
    v_cvt_pk_bf16_f32 v96, v96, v97
    v_mfma_f32_16x16x32_bf16 a[152:155], v[56:59], v[80:83], a[152:155]
    v_exp_f32 v104, v104
    v_mfma_f32_16x16x32_bf16 a[156:159], v[60:63], v[80:83], a[156:159]
    v_xor_b32 v14, 64, v13
    v_add_f32 v20, v20, v97
    v_mfma_f32_16x16x32_bf16 a[208:211], v[48:51], v[88:91], a[208:211]
    buffer_load_dwordx4 v14, s[20:23], s31 offen offset:1024 lds
    v_mfma_f32_16x16x32_bf16 a[212:215], v[52:55], v[88:91], a[212:215]
    v_exp_f32 v105, v105
    v_mfma_f32_16x16x32_bf16 a[216:219], v[56:59], v[88:91], a[216:219]
    v_exp_f32 v112, v112
    v_mfma_f32_16x16x32_bf16 a[220:223], v[60:63], v[88:91], a[220:223]
    v_exp_f32 v113, v113
    s_waitcnt lgkmcnt(0)
    v_mfma_f32_16x16x32_bf16 a[32:35], v[32:35], v[64:67], a[32:35]
    ds_read_b64_tr_b16 v[48:49], v8 offset:33024
    v_add_f32 v21, v21, v104
    v_mfma_f32_16x16x32_bf16 a[36:39], v[36:39], v[64:67], a[36:39]
    ds_read_b64_tr_b16 v[50:51], v8 offset:41216
    v_cvt_pk_bf16_f32 v104, v104, v105
    v_mfma_f32_16x16x32_bf16 a[40:43], v[40:43], v[64:67], a[40:43]
    ds_read_b64_tr_b16 v[52:53], v9 offset:33024
    v_add_f32 v21, v21, v105
    v_mfma_f32_16x16x32_bf16 a[44:47], v[44:47], v[64:67], a[44:47]
    ds_read_b64_tr_b16 v[54:55], v9 offset:41216
    v_add_f32 v22, v22, v112
    v_mfma_f32_16x16x32_bf16 a[96:99], v[32:35], v[72:75], a[96:99]
    ds_read_b64_tr_b16 v[56:57], v10 offset:33024
    v_mfma_f32_16x16x32_bf16 a[100:103], v[36:39], v[72:75], a[100:103]
    ds_read_b64_tr_b16 v[58:59], v10 offset:41216
    v_cvt_pk_bf16_f32 v112, v112, v113
    v_mfma_f32_16x16x32_bf16 a[104:107], v[40:43], v[72:75], a[104:107]
    ds_read_b64_tr_b16 v[60:61], v11 offset:33024
    v_add_f32 v22, v22, v113
    v_mfma_f32_16x16x32_bf16 a[108:111], v[44:47], v[72:75], a[108:111]
    ds_read_b64_tr_b16 v[62:63], v11 offset:41216
    v_fma_f32 v99, v99, s28, v16
    v_mfma_f32_16x16x32_bf16 a[160:163], v[32:35], v[80:83], a[160:163]
    v_xor_b32 v14, 128, v13
    v_fma_f32 v106, v106, s28, v17
    v_mfma_f32_16x16x32_bf16 a[164:167], v[36:39], v[80:83], a[164:167]
    buffer_load_dwordx4 v14, s[20:23], s31 offen offset:2048 lds
    v_mfma_f32_16x16x32_bf16 a[168:171], v[40:43], v[80:83], a[168:171]
    v_exp_f32 v120, v120
    v_mfma_f32_16x16x32_bf16 a[172:175], v[44:47], v[80:83], a[172:175]
    v_exp_f32 v121, v121
    v_mfma_f32_16x16x32_bf16 a[224:227], v[32:35], v[88:91], a[224:227]
    v_exp_f32 v98, v98
    v_mfma_f32_16x16x32_bf16 a[228:231], v[36:39], v[88:91], a[228:231]
    v_exp_f32 v99, v99
    v_mfma_f32_16x16x32_bf16 a[232:235], v[40:43], v[88:91], a[232:235]
    v_exp_f32 v106, v106
    v_mfma_f32_16x16x32_bf16 a[236:239], v[44:47], v[88:91], a[236:239]
    v_add_f32 v23, v23, v120
    v_cvt_pk_bf16_f32 v120, v120, v121
    s_waitcnt lgkmcnt(0)
    v_mfma_f32_16x16x32_bf16 a[48:51], v[48:51], v[64:67], a[48:51]
    ds_read_b128 v[32:35], v0 offset:0
    v_add_f32 v23, v23, v121
    v_mfma_f32_16x16x32_bf16 a[52:55], v[52:55], v[64:67], a[52:55]
    ds_read_b128 v[36:39], v1 offset:0
    v_add_f32 v20, v20, v98
    v_mfma_f32_16x16x32_bf16 a[56:59], v[56:59], v[64:67], a[56:59]
    ds_read_b128 v[40:43], v2 offset:0
    v_cvt_pk_bf16_f32 v97, v98, v99
    v_mfma_f32_16x16x32_bf16 a[60:63], v[60:63], v[64:67], a[60:63]
    ds_read_b128 v[44:47], v3 offset:0
    v_add_f32 v20, v20, v99
    v_mfma_f32_16x16x32_bf16 a[112:115], v[48:51], v[72:75], a[112:115]
    v_fma_f32 v107, v107, s28, v17
    v_add_f32 v21, v21, v106
    v_mfma_f32_16x16x32_bf16 a[116:119], v[52:55], v[72:75], a[116:119]
    v_xor_b32 v14, 192, v13
    v_fma_f32 v114, v114, s28, v18
    v_mfma_f32_16x16x32_bf16 a[120:123], v[56:59], v[72:75], a[120:123]
    buffer_load_dwordx4 v14, s[20:23], s31 offen offset:3072 lds
    s_add_u32 s31, s31, 16384
    v_mfma_f32_16x16x32_bf16 a[124:127], v[60:63], v[72:75], a[124:127]
    v_exp_f32 v107, v107
    v_mfma_f32_16x16x32_bf16 a[176:179], v[48:51], v[80:83], a[176:179]
    v_exp_f32 v114, v114
    v_mfma_f32_16x16x32_bf16 a[180:183], v[52:55], v[80:83], a[180:183]
    v_cvt_pk_bf16_f32 v105, v106, v107
    v_add_f32 v21, v21, v107
    v_mfma_f32_16x16x32_bf16 a[184:187], v[56:59], v[80:83], a[184:187]
    v_fma_f32 v115, v115, s28, v18
    v_add_f32 v22, v22, v114
    v_mfma_f32_16x16x32_bf16 a[188:191], v[60:63], v[80:83], a[188:191]
    v_exp_f32 v115, v115
    v_mfma_f32_16x16x32_bf16 a[240:243], v[48:51], v[88:91], a[240:243]
    v_cvt_pk_bf16_f32 v113, v114, v115
    v_add_f32 v22, v22, v115
    v_mfma_f32_16x16x32_bf16 a[244:247], v[52:55], v[88:91], a[244:247]
    v_fma_f32 v122, v122, s28, v19
    v_fma_f32 v123, v123, s28, v19
    v_mfma_f32_16x16x32_bf16 a[248:251], v[56:59], v[88:91], a[248:251]
    v_exp_f32 v122, v122
    v_mfma_f32_16x16x32_bf16 a[252:255], v[60:63], v[88:91], a[252:255]
    v_exp_f32 v123, v123
    s_cmp_eq_u32 s33, 0
    s_cbranch_scc0 L_skipB_2_stub
L_skipB_2:
    s_waitcnt lgkmcnt(0)
    v_mfma_f32_16x16x32_bf16 v[64:67], v[32:35], v[128:131], 0
    ds_read_b128 v[48:51], v0 offset:256
    v_add_f32 v23, v23, v122
    v_mfma_f32_16x16x32_bf16 v[64:67], v[36:39], v[132:135], v[64:67]
    ds_read_b128 v[52:55], v1 offset:256
    v_cvt_pk_bf16_f32 v121, v122, v123
    v_mfma_f32_16x16x32_bf16 v[64:67], v[40:43], v[136:139], v[64:67]
    ds_read_b128 v[56:59], v2 offset:256
    v_add_f32 v23, v23, v123
    v_mfma_f32_16x16x32_bf16 v[64:67], v[44:47], v[140:143], v[64:67]
    ds_read_b128 v[60:63], v3 offset:256
    v_fma_f32 v100, v100, s28, v16
    v_mfma_f32_16x16x32_bf16 v[72:75], v[32:35], v[160:163], 0
    v_exp_f32 v100, v100
    v_mfma_f32_16x16x32_bf16 v[72:75], v[36:39], v[164:167], v[72:75]
    s_add_u32 m0, s29, 49152
    s_nop 0
    buffer_load_dwordx4 v12, s[16:19], s30 offen offset:0 lds
    v_mfma_f32_16x16x32_bf16 v[72:75], v[40:43], v[168:171], v[72:75]
    v_fma_f32 v101, v101, s28, v16
    v_add_f32 v20, v20, v100
    v_mfma_f32_16x16x32_bf16 v[72:75], v[44:47], v[172:175], v[72:75]
    v_exp_f32 v101, v101
    v_mfma_f32_16x16x32_bf16 v[80:83], v[32:35], v[192:195], 0
    v_cvt_pk_bf16_f32 v98, v100, v101
    v_add_f32 v20, v20, v101
    v_mfma_f32_16x16x32_bf16 v[80:83], v[36:39], v[196:199], v[80:83]
    v_fma_f32 v108, v108, s28, v17
    v_fma_f32 v109, v109, s28, v17
    v_mfma_f32_16x16x32_bf16 v[80:83], v[40:43], v[200:203], v[80:83]
    v_exp_f32 v108, v108
    v_mfma_f32_16x16x32_bf16 v[80:83], v[44:47], v[204:207], v[80:83]
    v_exp_f32 v109, v109
    v_mfma_f32_16x16x32_bf16 v[88:91], v[32:35], v[224:227], 0
    v_add_f32 v21, v21, v108
    v_cvt_pk_bf16_f32 v106, v108, v109
    v_mfma_f32_16x16x32_bf16 v[88:91], v[36:39], v[228:231], v[88:91]
    v_add_f32 v21, v21, v109
    v_fma_f32 v116, v116, s28, v18
    v_mfma_f32_16x16x32_bf16 v[88:91], v[40:43], v[232:235], v[88:91]
    v_exp_f32 v116, v116
    v_mfma_f32_16x16x32_bf16 v[88:91], v[44:47], v[236:239], v[88:91]
    v_fma_f32 v117, v117, s28, v18
    v_add_f32 v22, v22, v116
    s_waitcnt lgkmcnt(0)
    v_mfma_f32_16x16x32_bf16 v[64:67], v[48:51], v[144:147], v[64:67]
    ds_read_b128 v[32:35], v0 offset:8192
    v_xor_b32 v14, 32, v12
    v_mfma_f32_16x16x32_bf16 v[64:67], v[52:55], v[148:151], v[64:67]
    ds_read_b128 v[36:39], v1 offset:8192
    v_fma_f32 v124, v124, s28, v19
    v_mfma_f32_16x16x32_bf16 v[64:67], v[56:59], v[152:155], v[64:67]
    ds_read_b128 v[40:43], v2 offset:8192
    v_fma_f32 v125, v125, s28, v19
    v_mfma_f32_16x16x32_bf16 v[64:67], v[60:63], v[156:159], v[64:67]
    ds_read_b128 v[44:47], v3 offset:8192
    v_fma_f32 v102, v102, s28, v16
    v_mfma_f32_16x16x32_bf16 v[72:75], v[48:51], v[176:179], v[72:75]
    buffer_load_dwordx4 v14, s[16:19], s30 offen offset:1024 lds
    v_mfma_f32_16x16x32_bf16 v[72:75], v[52:55], v[180:183], v[72:75]
    v_exp_f32 v117, v117
    v_mfma_f32_16x16x32_bf16 v[72:75], v[56:59], v[184:187], v[72:75]
    v_exp_f32 v124, v124
    v_mfma_f32_16x16x32_bf16 v[72:75], v[60:63], v[188:191], v[72:75]
    v_exp_f32 v125, v125
    v_mfma_f32_16x16x32_bf16 v[80:83], v[48:51], v[208:211], v[80:83]
    v_exp_f32 v102, v102
    v_mfma_f32_16x16x32_bf16 v[80:83], v[52:55], v[212:215], v[80:83]
    v_cvt_pk_bf16_f32 v114, v116, v117
    v_add_f32 v22, v22, v117
    v_mfma_f32_16x16x32_bf16 v[80:83], v[56:59], v[216:219], v[80:83]
    v_add_f32 v23, v23, v124
    v_cvt_pk_bf16_f32 v122, v124, v125
    v_mfma_f32_16x16x32_bf16 v[80:83], v[60:63], v[220:223], v[80:83]
    v_xor_b32 v14, 64, v12
    v_add_f32 v23, v23, v125
    v_mfma_f32_16x16x32_bf16 v[88:91], v[48:51], v[240:243], v[88:91]
    buffer_load_dwordx4 v14, s[16:19], s30 offen offset:2048 lds
    v_mfma_f32_16x16x32_bf16 v[88:91], v[52:55], v[244:247], v[88:91]
    v_fma_f32 v103, v103, s28, v16
    v_add_f32 v20, v20, v102
    v_mfma_f32_16x16x32_bf16 v[88:91], v[56:59], v[248:251], v[88:91]
    v_exp_f32 v103, v103
    v_mfma_f32_16x16x32_bf16 v[88:91], v[60:63], v[252:255], v[88:91]
    v_cvt_pk_bf16_f32 v99, v102, v103
    v_add_f32 v20, v20, v103
    s_waitcnt lgkmcnt(0)
    v_mfma_f32_16x16x32_bf16 v[68:71], v[32:35], v[128:131], 0
    ds_read_b128 v[48:51], v0 offset:8448
    v_fma_f32 v110, v110, s28, v17
    v_mfma_f32_16x16x32_bf16 v[68:71], v[36:39], v[132:135], v[68:71]
    ds_read_b128 v[52:55], v1 offset:8448
    v_fma_f32 v111, v111, s28, v17
    v_mfma_f32_16x16x32_bf16 v[68:71], v[40:43], v[136:139], v[68:71]
    ds_read_b128 v[56:59], v2 offset:8448
    v_fma_f32 v118, v118, s28, v18
    v_mfma_f32_16x16x32_bf16 v[68:71], v[44:47], v[140:143], v[68:71]
    ds_read_b128 v[60:63], v3 offset:8448
    v_fma_f32 v119, v119, s28, v18
    v_mfma_f32_16x16x32_bf16 v[76:79], v[32:35], v[160:163], 0
    v_exp_f32 v110, v110
    v_mfma_f32_16x16x32_bf16 v[76:79], v[36:39], v[164:167], v[76:79]
    v_exp_f32 v111, v111
    v_mfma_f32_16x16x32_bf16 v[76:79], v[40:43], v[168:171], v[76:79]
    v_xor_b32 v14, 96, v12
    v_add_f32 v21, v21, v110
    v_mfma_f32_16x16x32_bf16 v[76:79], v[44:47], v[172:175], v[76:79]
    buffer_load_dwordx4 v14, s[16:19], s30 offen offset:3072 lds
    s_add_u32 s30, s30, 16384
    v_mfma_f32_16x16x32_bf16 v[84:87], v[32:35], v[192:195], 0
    v_exp_f32 v118, v118
    v_mfma_f32_16x16x32_bf16 v[84:87], v[36:39], v[196:199], v[84:87]
    v_exp_f32 v119, v119
    v_mfma_f32_16x16x32_bf16 v[84:87], v[40:43], v[200:203], v[84:87]
    v_cvt_pk_bf16_f32 v107, v110, v111
    v_add_f32 v21, v21, v111
    v_mfma_f32_16x16x32_bf16 v[84:87], v[44:47], v[204:207], v[84:87]
    v_add_f32 v22, v22, v118
    v_cvt_pk_bf16_f32 v115, v118, v119
    v_mfma_f32_16x16x32_bf16 v[92:95], v[32:35], v[224:227], 0
    v_add_f32 v22, v22, v119
    v_fma_f32 v126, v126, s28, v19
    v_mfma_f32_16x16x32_bf16 v[92:95], v[36:39], v[228:231], v[92:95]
    v_exp_f32 v126, v126
    v_mfma_f32_16x16x32_bf16 v[92:95], v[40:43], v[232:235], v[92:95]
    v_fma_f32 v127, v127, s28, v19
    v_add_f32 v23, v23, v126
    v_mfma_f32_16x16x32_bf16 v[92:95], v[44:47], v[236:239], v[92:95]
    v_exp_f32 v127, v127
    s_waitcnt lgkmcnt(0)
    v_mfma_f32_16x16x32_bf16 v[68:71], v[48:51], v[144:147], v[68:71]
    ds_read_b64_tr_b16 v[32:33], v4 offset:49152
    v_cvt_pk_bf16_f32 v123, v126, v127
    v_mfma_f32_16x16x32_bf16 v[68:71], v[52:55], v[148:151], v[68:71]
    ds_read_b64_tr_b16 v[34:35], v4 offset:57344
    v_add_f32 v23, v23, v127
    v_mfma_f32_16x16x32_bf16 v[68:71], v[56:59], v[152:155], v[68:71]
    ds_read_b64_tr_b16 v[36:37], v5 offset:49152
    v_max3_f32 v24, v64, v65, v66
    s_waitcnt vmcnt(12)
    s_barrier
    v_mfma_f32_16x16x32_bf16 v[68:71], v[60:63], v[156:159], v[68:71]
    ds_read_b64_tr_b16 v[38:39], v5 offset:57344
    v_max3_f32 v25, v72, v73, v74
    v_mfma_f32_16x16x32_bf16 v[76:79], v[48:51], v[176:179], v[76:79]
    ds_read_b64_tr_b16 v[40:41], v6 offset:49152
    v_max3_f32 v26, v80, v81, v82
    v_mfma_f32_16x16x32_bf16 v[76:79], v[52:55], v[180:183], v[76:79]
    ds_read_b64_tr_b16 v[42:43], v6 offset:57344
    v_max3_f32 v27, v88, v89, v90
    v_mfma_f32_16x16x32_bf16 v[76:79], v[56:59], v[184:187], v[76:79]
    ds_read_b64_tr_b16 v[44:45], v7 offset:49152
    v_max_f32 v24, v24, v67
    v_mfma_f32_16x16x32_bf16 v[76:79], v[60:63], v[188:191], v[76:79]
    ds_read_b64_tr_b16 v[46:47], v7 offset:57344
    v_max_f32 v25, v25, v75
    v_mfma_f32_16x16x32_bf16 v[84:87], v[48:51], v[208:211], v[84:87]
    v_max_f32 v26, v26, v83
    v_max_f32 v27, v27, v91
    v_mfma_f32_16x16x32_bf16 v[84:87], v[52:55], v[212:215], v[84:87]
    v_mfma_f32_16x16x32_bf16 v[84:87], v[56:59], v[216:219], v[84:87]
    v_mfma_f32_16x16x32_bf16 v[84:87], v[60:63], v[220:223], v[84:87]
    v_mfma_f32_16x16x32_bf16 v[92:95], v[48:51], v[240:243], v[92:95]
    v_mfma_f32_16x16x32_bf16 v[92:95], v[52:55], v[244:247], v[92:95]
    v_mfma_f32_16x16x32_bf16 v[92:95], v[56:59], v[248:251], v[92:95]
    v_mfma_f32_16x16x32_bf16 v[92:95], v[60:63], v[252:255], v[92:95]
    s_waitcnt lgkmcnt(0)
    v_mfma_f32_16x16x32_bf16 a[0:3], v[32:35], v[96:99], a[0:3]
    ds_read_b64_tr_b16 v[48:49], v8 offset:49152
    v_mfma_f32_16x16x32_bf16 a[4:7], v[36:39], v[96:99], a[4:7]
    ds_read_b64_tr_b16 v[50:51], v8 offset:57344
    v_mfma_f32_16x16x32_bf16 a[8:11], v[40:43], v[96:99], a[8:11]
    ds_read_b64_tr_b16 v[52:53], v9 offset:49152
    v_max3_f32 v24, v24, v68, v69
    v_mfma_f32_16x16x32_bf16 a[12:15], v[44:47], v[96:99], a[12:15]
    ds_read_b64_tr_b16 v[54:55], v9 offset:57344
    v_max3_f32 v25, v25, v76, v77
    v_mfma_f32_16x16x32_bf16 a[64:67], v[32:35], v[104:107], a[64:67]
    ds_read_b64_tr_b16 v[56:57], v10 offset:49152
    v_max3_f32 v26, v26, v84, v85
    v_mfma_f32_16x16x32_bf16 a[68:71], v[36:39], v[104:107], a[68:71]
    ds_read_b64_tr_b16 v[58:59], v10 offset:57344
    v_max3_f32 v27, v27, v92, v93
    v_mfma_f32_16x16x32_bf16 a[72:75], v[40:43], v[104:107], a[72:75]
    ds_read_b64_tr_b16 v[60:61], v11 offset:49152
    v_max3_f32 v24, v24, v70, v71
    v_mfma_f32_16x16x32_bf16 a[76:79], v[44:47], v[104:107], a[76:79]
    ds_read_b64_tr_b16 v[62:63], v11 offset:57344
    v_max3_f32 v25, v25, v78, v79
    v_mfma_f32_16x16x32_bf16 a[128:131], v[32:35], v[112:115], a[128:131]
    v_max3_f32 v26, v26, v86, v87
    v_max3_f32 v27, v27, v94, v95
    v_mfma_f32_16x16x32_bf16 a[132:135], v[36:39], v[112:115], a[132:135]
    v_fma_f32 v28, v24, s28, v16
    v_fma_f32 v29, v25, s28, v17
    v_mfma_f32_16x16x32_bf16 a[136:139], v[40:43], v[112:115], a[136:139]
    v_fma_f32 v30, v26, s28, v18
    v_fma_f32 v31, v27, s28, v19
    v_mfma_f32_16x16x32_bf16 a[140:143], v[44:47], v[112:115], a[140:143]
    v_max3_f32 v28, v28, v29, v30
    v_max_f32 v28, v28, v31
    v_mfma_f32_16x16x32_bf16 a[192:195], v[32:35], v[120:123], a[192:195]
    v_cmp_lt_f32 vcc, 0x41000000, v28
    s_cbranch_vccnz L_skipA_3_stub
L_skipA_3:
    v_mfma_f32_16x16x32_bf16 a[196:199], v[36:39], v[120:123], a[196:199]
    v_fma_f32 v64, v64, s28, v16
    v_fma_f32 v65, v65, s28, v16
    v_mfma_f32_16x16x32_bf16 a[200:203], v[40:43], v[120:123], a[200:203]
    s_add_u32 m0, s29, 98304
    s_nop 0
    buffer_load_dwordx4 v13, s[20:23], s31 offen offset:0 lds
    v_mfma_f32_16x16x32_bf16 a[204:207], v[44:47], v[120:123], a[204:207]
    v_exp_f32 v64, v64
    s_waitcnt lgkmcnt(0)
    v_mfma_f32_16x16x32_bf16 a[16:19], v[48:51], v[96:99], a[16:19]
    ds_read_b64_tr_b16 v[32:33], v4 offset:49408
    v_add_f32 v20, v20, v64
    v_mfma_f32_16x16x32_bf16 a[20:23], v[52:55], v[96:99], a[20:23]
    ds_read_b64_tr_b16 v[34:35], v4 offset:57600
    v_fma_f32 v72, v72, s28, v17
    v_mfma_f32_16x16x32_bf16 a[24:27], v[56:59], v[96:99], a[24:27]
    ds_read_b64_tr_b16 v[36:37], v5 offset:49408
    v_fma_f32 v73, v73, s28, v17
    v_mfma_f32_16x16x32_bf16 a[28:31], v[60:63], v[96:99], a[28:31]
    ds_read_b64_tr_b16 v[38:39], v5 offset:57600
    v_fma_f32 v80, v80, s28, v18
    v_mfma_f32_16x16x32_bf16 a[80:83], v[48:51], v[104:107], a[80:83]
    ds_read_b64_tr_b16 v[40:41], v6 offset:49408
    v_fma_f32 v81, v81, s28, v18
    v_mfma_f32_16x16x32_bf16 a[84:87], v[52:55], v[104:107], a[84:87]
    ds_read_b64_tr_b16 v[42:43], v6 offset:57600
    v_fma_f32 v88, v88, s28, v19
    v_mfma_f32_16x16x32_bf16 a[88:91], v[56:59], v[104:107], a[88:91]
    ds_read_b64_tr_b16 v[44:45], v7 offset:49408
    v_fma_f32 v89, v89, s28, v19
    v_mfma_f32_16x16x32_bf16 a[92:95], v[60:63], v[104:107], a[92:95]
    ds_read_b64_tr_b16 v[46:47], v7 offset:57600
    v_fma_f32 v66, v66, s28, v16
    v_mfma_f32_16x16x32_bf16 a[144:147], v[48:51], v[112:115], a[144:147]
    v_exp_f32 v65, v65
    v_mfma_f32_16x16x32_bf16 a[148:151], v[52:55], v[112:115], a[148:151]
    v_cvt_pk_bf16_f32 v64, v64, v65
    v_mfma_f32_16x16x32_bf16 a[152:155], v[56:59], v[112:115], a[152:155]
    v_exp_f32 v72, v72
    v_mfma_f32_16x16x32_bf16 a[156:159], v[60:63], v[112:115], a[156:159]
    v_xor_b32 v14, 64, v13
    v_add_f32 v20, v20, v65
    v_mfma_f32_16x16x32_bf16 a[208:211], v[48:51], v[120:123], a[208:211]
    buffer_load_dwordx4 v14, s[20:23], s31 offen offset:1024 lds
    v_mfma_f32_16x16x32_bf16 a[212:215], v[52:55], v[120:123], a[212:215]
    v_exp_f32 v73, v73
    v_mfma_f32_16x16x32_bf16 a[216:219], v[56:59], v[120:123], a[216:219]
    v_exp_f32 v80, v80
    v_mfma_f32_16x16x32_bf16 a[220:223], v[60:63], v[120:123], a[220:223]
    v_exp_f32 v81, v81
    s_waitcnt lgkmcnt(0)
    v_mfma_f32_16x16x32_bf16 a[32:35], v[32:35], v[96:99], a[32:35]
    ds_read_b64_tr_b16 v[48:49], v8 offset:49408
    v_add_f32 v21, v21, v72
    v_mfma_f32_16x16x32_bf16 a[36:39], v[36:39], v[96:99], a[36:39]
    ds_read_b64_tr_b16 v[50:51], v8 offset:57600
    v_cvt_pk_bf16_f32 v72, v72, v73
    v_mfma_f32_16x16x32_bf16 a[40:43], v[40:43], v[96:99], a[40:43]
    ds_read_b64_tr_b16 v[52:53], v9 offset:49408
    v_add_f32 v21, v21, v73
    v_mfma_f32_16x16x32_bf16 a[44:47], v[44:47], v[96:99], a[44:47]
    ds_read_b64_tr_b16 v[54:55], v9 offset:57600
    v_add_f32 v22, v22, v80
    v_mfma_f32_16x16x32_bf16 a[96:99], v[32:35], v[104:107], a[96:99]
    ds_read_b64_tr_b16 v[56:57], v10 offset:49408
    v_mfma_f32_16x16x32_bf16 a[100:103], v[36:39], v[104:107], a[100:103]
    ds_read_b64_tr_b16 v[58:59], v10 offset:57600
    v_cvt_pk_bf16_f32 v80, v80, v81
    v_mfma_f32_16x16x32_bf16 a[104:107], v[40:43], v[104:107], a[104:107]
    ds_read_b64_tr_b16 v[60:61], v11 offset:49408
    v_add_f32 v22, v22, v81
    v_mfma_f32_16x16x32_bf16 a[108:111], v[44:47], v[104:107], a[108:111]
    ds_read_b64_tr_b16 v[62:63], v11 offset:57600
    v_fma_f32 v67, v67, s28, v16
    v_mfma_f32_16x16x32_bf16 a[160:163], v[32:35], v[112:115], a[160:163]
    v_xor_b32 v14, 128, v13
    v_fma_f32 v74, v74, s28, v17
    v_mfma_f32_16x16x32_bf16 a[164:167], v[36:39], v[112:115], a[164:167]
    buffer_load_dwordx4 v14, s[20:23], s31 offen offset:2048 lds
    v_mfma_f32_16x16x32_bf16 a[168:171], v[40:43], v[112:115], a[168:171]
    v_exp_f32 v88, v88
    v_mfma_f32_16x16x32_bf16 a[172:175], v[44:47], v[112:115], a[172:175]
    v_exp_f32 v89, v89
    v_mfma_f32_16x16x32_bf16 a[224:227], v[32:35], v[120:123], a[224:227]
    v_exp_f32 v66, v66
    v_mfma_f32_16x16x32_bf16 a[228:231], v[36:39], v[120:123], a[228:231]
    v_exp_f32 v67, v67
    v_mfma_f32_16x16x32_bf16 a[232:235], v[40:43], v[120:123], a[232:235]
    v_exp_f32 v74, v74
    v_mfma_f32_16x16x32_bf16 a[236:239], v[44:47], v[120:123], a[236:239]
    v_add_f32 v23, v23, v88
    v_cvt_pk_bf16_f32 v88, v88, v89
    s_waitcnt lgkmcnt(0)
    v_mfma_f32_16x16x32_bf16 a[48:51], v[48:51], v[96:99], a[48:51]
    ds_read_b128 v[32:35], v0 offset:16384
    v_add_f32 v23, v23, v89
    v_mfma_f32_16x16x32_bf16 a[52:55], v[52:55], v[96:99], a[52:55]
    ds_read_b128 v[36:39], v1 offset:16384
    v_add_f32 v20, v20, v66
    v_mfma_f32_16x16x32_bf16 a[56:59], v[56:59], v[96:99], a[56:59]
    ds_read_b128 v[40:43], v2 offset:16384
    v_cvt_pk_bf16_f32 v65, v66, v67
    v_mfma_f32_16x16x32_bf16 a[60:63], v[60:63], v[96:99], a[60:63]
    ds_read_b128 v[44:47], v3 offset:16384
    v_add_f32 v20, v20, v67
    v_mfma_f32_16x16x32_bf16 a[112:115], v[48:51], v[104:107], a[112:115]
    v_fma_f32 v75, v75, s28, v17
    v_add_f32 v21, v21, v74
    v_mfma_f32_16x16x32_bf16 a[116:119], v[52:55], v[104:107], a[116:119]
    v_xor_b32 v14, 192, v13
    v_fma_f32 v82, v82, s28, v18
    v_mfma_f32_16x16x32_bf16 a[120:123], v[56:59], v[104:107], a[120:123]
    buffer_load_dwordx4 v14, s[20:23], s31 offen offset:3072 lds
    s_add_u32 s31, s31, 16384
    v_mfma_f32_16x16x32_bf16 a[124:127], v[60:63], v[104:107], a[124:127]
    v_exp_f32 v75, v75
    v_mfma_f32_16x16x32_bf16 a[176:179], v[48:51], v[112:115], a[176:179]
    v_exp_f32 v82, v82
    v_mfma_f32_16x16x32_bf16 a[180:183], v[52:55], v[112:115], a[180:183]
    v_cvt_pk_bf16_f32 v73, v74, v75
    v_add_f32 v21, v21, v75
    v_mfma_f32_16x16x32_bf16 a[184:187], v[56:59], v[112:115], a[184:187]
    v_fma_f32 v83, v83, s28, v18
    v_add_f32 v22, v22, v82
    v_mfma_f32_16x16x32_bf16 a[188:191], v[60:63], v[112:115], a[188:191]
    v_exp_f32 v83, v83
    v_mfma_f32_16x16x32_bf16 a[240:243], v[48:51], v[120:123], a[240:243]
    v_cvt_pk_bf16_f32 v81, v82, v83
    v_add_f32 v22, v22, v83
    v_mfma_f32_16x16x32_bf16 a[244:247], v[52:55], v[120:123], a[244:247]
    v_fma_f32 v90, v90, s28, v19
    v_fma_f32 v91, v91, s28, v19
    v_mfma_f32_16x16x32_bf16 a[248:251], v[56:59], v[120:123], a[248:251]
    v_exp_f32 v90, v90
    v_mfma_f32_16x16x32_bf16 a[252:255], v[60:63], v[120:123], a[252:255]
    v_exp_f32 v91, v91
    s_cmp_eq_u32 s33, 0
    s_cbranch_scc0 L_skipB_3_stub
L_skipB_3:
    s_sub_u32 s32, s32, 1
    s_cmp_lg_u32 s32, 0
    s_cbranch_scc1 L_loop
    s_waitcnt lgkmcnt(0)
    v_mfma_f32_16x16x32_bf16 v[96:99], v[32:35], v[128:131], 0
    ds_read_b128 v[48:51], v0 offset:16640
    v_add_f32 v23, v23, v90
    v_mfma_f32_16x16x32_bf16 v[96:99], v[36:39], v[132:135], v[96:99]
    ds_read_b128 v[52:55], v1 offset:16640
    v_cvt_pk_bf16_f32 v89, v90, v91
    v_mfma_f32_16x16x32_bf16 v[96:99], v[40:43], v[136:139], v[96:99]
    ds_read_b128 v[56:59], v2 offset:16640
    v_add_f32 v23, v23, v91
    v_mfma_f32_16x16x32_bf16 v[96:99], v[44:47], v[140:143], v[96:99]
    ds_read_b128 v[60:63], v3 offset:16640
    v_fma_f32 v68, v68, s28, v16
    v_mfma_f32_16x16x32_bf16 v[104:107], v[32:35], v[160:163], 0
    v_exp_f32 v68, v68
    v_mfma_f32_16x16x32_bf16 v[104:107], v[36:39], v[164:167], v[104:107]
    v_mfma_f32_16x16x32_bf16 v[104:107], v[40:43], v[168:171], v[104:107]
    v_fma_f32 v69, v69, s28, v16
    v_add_f32 v20, v20, v68
    v_mfma_f32_16x16x32_bf16 v[104:107], v[44:47], v[172:175], v[104:107]
    v_exp_f32 v69, v69
    v_mfma_f32_16x16x32_bf16 v[112:115], v[32:35], v[192:195], 0
    v_cvt_pk_bf16_f32 v66, v68, v69
    v_add_f32 v20, v20, v69
    v_mfma_f32_16x16x32_bf16 v[112:115], v[36:39], v[196:199], v[112:115]
    v_fma_f32 v76, v76, s28, v17
    v_fma_f32 v77, v77, s28, v17
    v_mfma_f32_16x16x32_bf16 v[112:115], v[40:43], v[200:203], v[112:115]
    v_exp_f32 v76, v76
    v_mfma_f32_16x16x32_bf16 v[112:115], v[44:47], v[204:207], v[112:115]
    v_exp_f32 v77, v77
    v_mfma_f32_16x16x32_bf16 v[120:123], v[32:35], v[224:227], 0
    v_add_f32 v21, v21, v76
    v_cvt_pk_bf16_f32 v74, v76, v77
    v_mfma_f32_16x16x32_bf16 v[120:123], v[36:39], v[228:231], v[120:123]
    v_add_f32 v21, v21, v77
    v_fma_f32 v84, v84, s28, v18
    v_mfma_f32_16x16x32_bf16 v[120:123], v[40:43], v[232:235], v[120:123]
    v_exp_f32 v84, v84
    v_mfma_f32_16x16x32_bf16 v[120:123], v[44:47], v[236:239], v[120:123]
    v_fma_f32 v85, v85, s28, v18
    v_add_f32 v22, v22, v84
    s_waitcnt lgkmcnt(0)
    v_mfma_f32_16x16x32_bf16 v[96:99], v[48:51], v[144:147], v[96:99]
    ds_read_b128 v[32:35], v0 offset:24576
    v_mfma_f32_16x16x32_bf16 v[96:99], v[52:55], v[148:151], v[96:99]
    ds_read_b128 v[36:39], v1 offset:24576
    v_fma_f32 v92, v92, s28, v19
    v_mfma_f32_16x16x32_bf16 v[96:99], v[56:59], v[152:155], v[96:99]
    ds_read_b128 v[40:43], v2 offset:24576
    v_fma_f32 v93, v93, s28, v19
    v_mfma_f32_16x16x32_bf16 v[96:99], v[60:63], v[156:159], v[96:99]
    ds_read_b128 v[44:47], v3 offset:24576
    v_fma_f32 v70, v70, s28, v16
    v_mfma_f32_16x16x32_bf16 v[104:107], v[48:51], v[176:179], v[104:107]
    v_mfma_f32_16x16x32_bf16 v[104:107], v[52:55], v[180:183], v[104:107]
    v_exp_f32 v85, v85
    v_mfma_f32_16x16x32_bf16 v[104:107], v[56:59], v[184:187], v[104:107]
    v_exp_f32 v92, v92
    v_mfma_f32_16x16x32_bf16 v[104:107], v[60:63], v[188:191], v[104:107]
    v_exp_f32 v93, v93
    v_mfma_f32_16x16x32_bf16 v[112:115], v[48:51], v[208:211], v[112:115]
    v_exp_f32 v70, v70
    v_mfma_f32_16x16x32_bf16 v[112:115], v[52:55], v[212:215], v[112:115]
    v_cvt_pk_bf16_f32 v82, v84, v85
    v_add_f32 v22, v22, v85
    v_mfma_f32_16x16x32_bf16 v[112:115], v[56:59], v[216:219], v[112:115]
    v_add_f32 v23, v23, v92
    v_cvt_pk_bf16_f32 v90, v92, v93
    v_mfma_f32_16x16x32_bf16 v[112:115], v[60:63], v[220:223], v[112:115]
    v_add_f32 v23, v23, v93
    v_mfma_f32_16x16x32_bf16 v[120:123], v[48:51], v[240:243], v[120:123]
    v_mfma_f32_16x16x32_bf16 v[120:123], v[52:55], v[244:247], v[120:123]
    v_fma_f32 v71, v71, s28, v16
    v_add_f32 v20, v20, v70
    v_mfma_f32_16x16x32_bf16 v[120:123], v[56:59], v[248:251], v[120:123]
    v_exp_f32 v71, v71
    v_mfma_f32_16x16x32_bf16 v[120:123], v[60:63], v[252:255], v[120:123]
    v_cvt_pk_bf16_f32 v67, v70, v71
    v_add_f32 v20, v20, v71
    s_waitcnt lgkmcnt(0)
    v_mfma_f32_16x16x32_bf16 v[100:103], v[32:35], v[128:131], 0
    ds_read_b128 v[48:51], v0 offset:24832
    v_fma_f32 v78, v78, s28, v17
    v_mfma_f32_16x16x32_bf16 v[100:103], v[36:39], v[132:135], v[100:103]
    ds_read_b128 v[52:55], v1 offset:24832
    v_fma_f32 v79, v79, s28, v17
    v_mfma_f32_16x16x32_bf16 v[100:103], v[40:43], v[136:139], v[100:103]
    ds_read_b128 v[56:59], v2 offset:24832
    v_fma_f32 v86, v86, s28, v18
    v_mfma_f32_16x16x32_bf16 v[100:103], v[44:47], v[140:143], v[100:103]
    ds_read_b128 v[60:63], v3 offset:24832
    v_fma_f32 v87, v87, s28, v18
    v_mfma_f32_16x16x32_bf16 v[108:111], v[32:35], v[160:163], 0
    v_exp_f32 v78, v78
    v_mfma_f32_16x16x32_bf16 v[108:111], v[36:39], v[164:167], v[108:111]
    v_exp_f32 v79, v79
    v_mfma_f32_16x16x32_bf16 v[108:111], v[40:43], v[168:171], v[108:111]
    v_add_f32 v21, v21, v78
    v_mfma_f32_16x16x32_bf16 v[108:111], v[44:47], v[172:175], v[108:111]
    v_mfma_f32_16x16x32_bf16 v[116:119], v[32:35], v[192:195], 0
    v_exp_f32 v86, v86
    v_mfma_f32_16x16x32_bf16 v[116:119], v[36:39], v[196:199], v[116:119]
    v_exp_f32 v87, v87
    v_mfma_f32_16x16x32_bf16 v[116:119], v[40:43], v[200:203], v[116:119]
    v_cvt_pk_bf16_f32 v75, v78, v79
    v_add_f32 v21, v21, v79
    v_mfma_f32_16x16x32_bf16 v[116:119], v[44:47], v[204:207], v[116:119]
    v_add_f32 v22, v22, v86
    v_cvt_pk_bf16_f32 v83, v86, v87
    v_mfma_f32_16x16x32_bf16 v[124:127], v[32:35], v[224:227], 0
    v_add_f32 v22, v22, v87
    v_fma_f32 v94, v94, s28, v19
    v_mfma_f32_16x16x32_bf16 v[124:127], v[36:39], v[228:231], v[124:127]
    v_exp_f32 v94, v94
    v_mfma_f32_16x16x32_bf16 v[124:127], v[40:43], v[232:235], v[124:127]
    v_fma_f32 v95, v95, s28, v19
    v_add_f32 v23, v23, v94
    v_mfma_f32_16x16x32_bf16 v[124:127], v[44:47], v[236:239], v[124:127]
    v_exp_f32 v95, v95
    s_waitcnt lgkmcnt(0)
    v_mfma_f32_16x16x32_bf16 v[100:103], v[48:51], v[144:147], v[100:103]
    ds_read_b64_tr_b16 v[32:33], v4 offset:0
    v_cvt_pk_bf16_f32 v91, v94, v95
    v_mfma_f32_16x16x32_bf16 v[100:103], v[52:55], v[148:151], v[100:103]
    ds_read_b64_tr_b16 v[34:35], v4 offset:8192
    v_add_f32 v23, v23, v95
    v_mfma_f32_16x16x32_bf16 v[100:103], v[56:59], v[152:155], v[100:103]
    ds_read_b64_tr_b16 v[36:37], v5 offset:0
    v_max3_f32 v24, v96, v97, v98
    s_waitcnt vmcnt(8)
    s_barrier
    v_mfma_f32_16x16x32_bf16 v[100:103], v[60:63], v[156:159], v[100:103]
    ds_read_b64_tr_b16 v[38:39], v5 offset:8192
    v_max3_f32 v25, v104, v105, v106
    v_mfma_f32_16x16x32_bf16 v[108:111], v[48:51], v[176:179], v[108:111]
    ds_read_b64_tr_b16 v[40:41], v6 offset:0
    v_max3_f32 v26, v112, v113, v114
    v_mfma_f32_16x16x32_bf16 v[108:111], v[52:55], v[180:183], v[108:111]
    ds_read_b64_tr_b16 v[42:43], v6 offset:8192
    v_max3_f32 v27, v120, v121, v122
    v_mfma_f32_16x16x32_bf16 v[108:111], v[56:59], v[184:187], v[108:111]
    ds_read_b64_tr_b16 v[44:45], v7 offset:0
    v_max_f32 v24, v24, v99
    v_mfma_f32_16x16x32_bf16 v[108:111], v[60:63], v[188:191], v[108:111]
    ds_read_b64_tr_b16 v[46:47], v7 offset:8192
    v_max_f32 v25, v25, v107
    v_mfma_f32_16x16x32_bf16 v[116:119], v[48:51], v[208:211], v[116:119]
    v_max_f32 v26, v26, v115
    v_max_f32 v27, v27, v123
    v_mfma_f32_16x16x32_bf16 v[116:119], v[52:55], v[212:215], v[116:119]
    v_mfma_f32_16x16x32_bf16 v[116:119], v[56:59], v[216:219], v[116:119]
    v_mfma_f32_16x16x32_bf16 v[116:119], v[60:63], v[220:223], v[116:119]
    v_mfma_f32_16x16x32_bf16 v[124:127], v[48:51], v[240:243], v[124:127]
    v_mfma_f32_16x16x32_bf16 v[124:127], v[52:55], v[244:247], v[124:127]
    v_mfma_f32_16x16x32_bf16 v[124:127], v[56:59], v[248:251], v[124:127]
    v_mfma_f32_16x16x32_bf16 v[124:127], v[60:63], v[252:255], v[124:127]
    s_waitcnt lgkmcnt(0)
    v_mfma_f32_16x16x32_bf16 a[0:3], v[32:35], v[64:67], a[0:3]
    ds_read_b64_tr_b16 v[48:49], v8 offset:0
    v_mfma_f32_16x16x32_bf16 a[4:7], v[36:39], v[64:67], a[4:7]
    ds_read_b64_tr_b16 v[50:51], v8 offset:8192
    v_mfma_f32_16x16x32_bf16 a[8:11], v[40:43], v[64:67], a[8:11]
    ds_read_b64_tr_b16 v[52:53], v9 offset:0
    v_max3_f32 v24, v24, v100, v101
    v_mfma_f32_16x16x32_bf16 a[12:15], v[44:47], v[64:67], a[12:15]
    ds_read_b64_tr_b16 v[54:55], v9 offset:8192
    v_max3_f32 v25, v25, v108, v109
    v_mfma_f32_16x16x32_bf16 a[64:67], v[32:35], v[72:75], a[64:67]
    ds_read_b64_tr_b16 v[56:57], v10 offset:0
    v_max3_f32 v26, v26, v116, v117
    v_mfma_f32_16x16x32_bf16 a[68:71], v[36:39], v[72:75], a[68:71]
    ds_read_b64_tr_b16 v[58:59], v10 offset:8192
    v_max3_f32 v27, v27, v124, v125
    v_mfma_f32_16x16x32_bf16 a[72:75], v[40:43], v[72:75], a[72:75]
    ds_read_b64_tr_b16 v[60:61], v11 offset:0
    v_max3_f32 v24, v24, v102, v103
    v_mfma_f32_16x16x32_bf16 a[76:79], v[44:47], v[72:75], a[76:79]
    ds_read_b64_tr_b16 v[62:63], v11 offset:8192
    v_max3_f32 v25, v25, v110, v111
    v_mfma_f32_16x16x32_bf16 a[128:131], v[32:35], v[80:83], a[128:131]
    v_max3_f32 v26, v26, v118, v119
    v_max3_f32 v27, v27, v126, v127
    v_mfma_f32_16x16x32_bf16 a[132:135], v[36:39], v[80:83], a[132:135]
    v_fma_f32 v28, v24, s28, v16
    v_fma_f32 v29, v25, s28, v17
    v_mfma_f32_16x16x32_bf16 a[136:139], v[40:43], v[80:83], a[136:139]
    v_fma_f32 v30, v26, s28, v18
    v_fma_f32 v31, v27, s28, v19
    v_mfma_f32_16x16x32_bf16 a[140:143], v[44:47], v[80:83], a[140:143]
    v_max3_f32 v28, v28, v29, v30
    v_max_f32 v28, v28, v31
    v_mfma_f32_16x16x32_bf16 a[192:195], v[32:35], v[88:91], a[192:195]
    v_cmp_lt_f32 vcc, 0x41000000, v28
    s_cbranch_vccnz L_skipA_28_stub
L_skipA_28:
    v_mfma_f32_16x16x32_bf16 a[196:199], v[36:39], v[88:91], a[196:199]
    v_fma_f32 v96, v96, s28, v16
    v_fma_f32 v97, v97, s28, v16
    v_mfma_f32_16x16x32_bf16 a[200:203], v[40:43], v[88:91], a[200:203]
    s_add_u32 m0, s29, 114688
    s_nop 0
    buffer_load_dwordx4 v13, s[20:23], s31 offen offset:0 lds
    v_mfma_f32_16x16x32_bf16 a[204:207], v[44:47], v[88:91], a[204:207]
    v_exp_f32 v96, v96
    s_waitcnt lgkmcnt(0)
    v_mfma_f32_16x16x32_bf16 a[16:19], v[48:51], v[64:67], a[16:19]
    ds_read_b64_tr_b16 v[32:33], v4 offset:256
    v_add_f32 v20, v20, v96
    v_mfma_f32_16x16x32_bf16 a[20:23], v[52:55], v[64:67], a[20:23]
    ds_read_b64_tr_b16 v[34:35], v4 offset:8448
    v_fma_f32 v104, v104, s28, v17
    v_mfma_f32_16x16x32_bf16 a[24:27], v[56:59], v[64:67], a[24:27]
    ds_read_b64_tr_b16 v[36:37], v5 offset:256
    v_fma_f32 v105, v105, s28, v17
    v_mfma_f32_16x16x32_bf16 a[28:31], v[60:63], v[64:67], a[28:31]
    ds_read_b64_tr_b16 v[38:39], v5 offset:8448
    v_fma_f32 v112, v112, s28, v18
    v_mfma_f32_16x16x32_bf16 a[80:83], v[48:51], v[72:75], a[80:83]
    ds_read_b64_tr_b16 v[40:41], v6 offset:256
    v_fma_f32 v113, v113, s28, v18
    v_mfma_f32_16x16x32_bf16 a[84:87], v[52:55], v[72:75], a[84:87]
    ds_read_b64_tr_b16 v[42:43], v6 offset:8448
    v_fma_f32 v120, v120, s28, v19
    v_mfma_f32_16x16x32_bf16 a[88:91], v[56:59], v[72:75], a[88:91]
    ds_read_b64_tr_b16 v[44:45], v7 offset:256
    v_fma_f32 v121, v121, s28, v19
    v_mfma_f32_16x16x32_bf16 a[92:95], v[60:63], v[72:75], a[92:95]
    ds_read_b64_tr_b16 v[46:47], v7 offset:8448
    v_fma_f32 v98, v98, s28, v16
    v_mfma_f32_16x16x32_bf16 a[144:147], v[48:51], v[80:83], a[144:147]
    v_exp_f32 v97, v97
    v_mfma_f32_16x16x32_bf16 a[148:151], v[52:55], v[80:83], a[148:151]
    v_cvt_pk_bf16_f32 v96, v96, v97
    v_mfma_f32_16x16x32_bf16 a[152:155], v[56:59], v[80:83], a[152:155]
    v_exp_f32 v104, v104
    v_mfma_f32_16x16x32_bf16 a[156:159], v[60:63], v[80:83], a[156:159]
    v_xor_b32 v14, 64, v13
    v_add_f32 v20, v20, v97
    v_mfma_f32_16x16x32_bf16 a[208:211], v[48:51], v[88:91], a[208:211]
    buffer_load_dwordx4 v14, s[20:23], s31 offen offset:1024 lds
    v_mfma_f32_16x16x32_bf16 a[212:215], v[52:55], v[88:91], a[212:215]
    v_exp_f32 v105, v105
    v_mfma_f32_16x16x32_bf16 a[216:219], v[56:59], v[88:91], a[216:219]
    v_exp_f32 v112, v112
    v_mfma_f32_16x16x32_bf16 a[220:223], v[60:63], v[88:91], a[220:223]
    v_exp_f32 v113, v113
    s_waitcnt lgkmcnt(0)
    v_mfma_f32_16x16x32_bf16 a[32:35], v[32:35], v[64:67], a[32:35]
    ds_read_b64_tr_b16 v[48:49], v8 offset:256
    v_add_f32 v21, v21, v104
    v_mfma_f32_16x16x32_bf16 a[36:39], v[36:39], v[64:67], a[36:39]
    ds_read_b64_tr_b16 v[50:51], v8 offset:8448
    v_cvt_pk_bf16_f32 v104, v104, v105
    v_mfma_f32_16x16x32_bf16 a[40:43], v[40:43], v[64:67], a[40:43]
    ds_read_b64_tr_b16 v[52:53], v9 offset:256
    v_add_f32 v21, v21, v105
    v_mfma_f32_16x16x32_bf16 a[44:47], v[44:47], v[64:67], a[44:47]
    ds_read_b64_tr_b16 v[54:55], v9 offset:8448
    v_add_f32 v22, v22, v112
    v_mfma_f32_16x16x32_bf16 a[96:99], v[32:35], v[72:75], a[96:99]
    ds_read_b64_tr_b16 v[56:57], v10 offset:256
    v_mfma_f32_16x16x32_bf16 a[100:103], v[36:39], v[72:75], a[100:103]
    ds_read_b64_tr_b16 v[58:59], v10 offset:8448
    v_cvt_pk_bf16_f32 v112, v112, v113
    v_mfma_f32_16x16x32_bf16 a[104:107], v[40:43], v[72:75], a[104:107]
    ds_read_b64_tr_b16 v[60:61], v11 offset:256
    v_add_f32 v22, v22, v113
    v_mfma_f32_16x16x32_bf16 a[108:111], v[44:47], v[72:75], a[108:111]
    ds_read_b64_tr_b16 v[62:63], v11 offset:8448
    v_fma_f32 v99, v99, s28, v16
    v_mfma_f32_16x16x32_bf16 a[160:163], v[32:35], v[80:83], a[160:163]
    v_xor_b32 v14, 128, v13
    v_fma_f32 v106, v106, s28, v17
    v_mfma_f32_16x16x32_bf16 a[164:167], v[36:39], v[80:83], a[164:167]
    buffer_load_dwordx4 v14, s[20:23], s31 offen offset:2048 lds
    v_mfma_f32_16x16x32_bf16 a[168:171], v[40:43], v[80:83], a[168:171]
    v_exp_f32 v120, v120
    v_mfma_f32_16x16x32_bf16 a[172:175], v[44:47], v[80:83], a[172:175]
    v_exp_f32 v121, v121
    v_mfma_f32_16x16x32_bf16 a[224:227], v[32:35], v[88:91], a[224:227]
    v_exp_f32 v98, v98
    v_mfma_f32_16x16x32_bf16 a[228:231], v[36:39], v[88:91], a[228:231]
    v_exp_f32 v99, v99
    v_mfma_f32_16x16x32_bf16 a[232:235], v[40:43], v[88:91], a[232:235]
    v_exp_f32 v106, v106
    v_mfma_f32_16x16x32_bf16 a[236:239], v[44:47], v[88:91], a[236:239]
    v_add_f32 v23, v23, v120
    v_cvt_pk_bf16_f32 v120, v120, v121
    s_waitcnt lgkmcnt(0)
    v_mfma_f32_16x16x32_bf16 a[48:51], v[48:51], v[64:67], a[48:51]
    ds_read_b128 v[32:35], v0 offset:32768
    v_add_f32 v23, v23, v121
    v_mfma_f32_16x16x32_bf16 a[52:55], v[52:55], v[64:67], a[52:55]
    ds_read_b128 v[36:39], v1 offset:32768
    v_add_f32 v20, v20, v98
    v_mfma_f32_16x16x32_bf16 a[56:59], v[56:59], v[64:67], a[56:59]
    ds_read_b128 v[40:43], v2 offset:32768
    v_cvt_pk_bf16_f32 v97, v98, v99
    v_mfma_f32_16x16x32_bf16 a[60:63], v[60:63], v[64:67], a[60:63]
    ds_read_b128 v[44:47], v3 offset:32768
    v_add_f32 v20, v20, v99
    v_mfma_f32_16x16x32_bf16 a[112:115], v[48:51], v[72:75], a[112:115]
    v_fma_f32 v107, v107, s28, v17
    v_add_f32 v21, v21, v106
    v_mfma_f32_16x16x32_bf16 a[116:119], v[52:55], v[72:75], a[116:119]
    v_xor_b32 v14, 192, v13
    v_fma_f32 v114, v114, s28, v18
    v_mfma_f32_16x16x32_bf16 a[120:123], v[56:59], v[72:75], a[120:123]
    buffer_load_dwordx4 v14, s[20:23], s31 offen offset:3072 lds
    s_add_u32 s31, s31, 16384
    v_mfma_f32_16x16x32_bf16 a[124:127], v[60:63], v[72:75], a[124:127]
    v_exp_f32 v107, v107
    v_mfma_f32_16x16x32_bf16 a[176:179], v[48:51], v[80:83], a[176:179]
    v_exp_f32 v114, v114
    v_mfma_f32_16x16x32_bf16 a[180:183], v[52:55], v[80:83], a[180:183]
    v_cvt_pk_bf16_f32 v105, v106, v107
    v_add_f32 v21, v21, v107
    v_mfma_f32_16x16x32_bf16 a[184:187], v[56:59], v[80:83], a[184:187]
    v_fma_f32 v115, v115, s28, v18
    v_add_f32 v22, v22, v114
    v_mfma_f32_16x16x32_bf16 a[188:191], v[60:63], v[80:83], a[188:191]
    v_exp_f32 v115, v115
    v_mfma_f32_16x16x32_bf16 a[240:243], v[48:51], v[88:91], a[240:243]
    v_cvt_pk_bf16_f32 v113, v114, v115
    v_add_f32 v22, v22, v115
    v_mfma_f32_16x16x32_bf16 a[244:247], v[52:55], v[88:91], a[244:247]
    v_fma_f32 v122, v122, s28, v19
    v_fma_f32 v123, v123, s28, v19
    v_mfma_f32_16x16x32_bf16 a[248:251], v[56:59], v[88:91], a[248:251]
    v_exp_f32 v122, v122
    v_mfma_f32_16x16x32_bf16 a[252:255], v[60:63], v[88:91], a[252:255]
    v_exp_f32 v123, v123
    s_cmp_eq_u32 s33, 0
    s_cbranch_scc0 L_skipB_28_stub
L_skipB_28:
    s_waitcnt lgkmcnt(0)
    v_mfma_f32_16x16x32_bf16 v[64:67], v[32:35], v[128:131], 0
    ds_read_b128 v[48:51], v0 offset:33024
    v_add_f32 v23, v23, v122
    v_mfma_f32_16x16x32_bf16 v[64:67], v[36:39], v[132:135], v[64:67]
    ds_read_b128 v[52:55], v1 offset:33024
    v_cvt_pk_bf16_f32 v121, v122, v123
    v_mfma_f32_16x16x32_bf16 v[64:67], v[40:43], v[136:139], v[64:67]
    ds_read_b128 v[56:59], v2 offset:33024
    v_add_f32 v23, v23, v123
    v_mfma_f32_16x16x32_bf16 v[64:67], v[44:47], v[140:143], v[64:67]
    ds_read_b128 v[60:63], v3 offset:33024
    v_fma_f32 v100, v100, s28, v16
    v_mfma_f32_16x16x32_bf16 v[72:75], v[32:35], v[160:163], 0
    v_exp_f32 v100, v100
    v_mfma_f32_16x16x32_bf16 v[72:75], v[36:39], v[164:167], v[72:75]
    v_mfma_f32_16x16x32_bf16 v[72:75], v[40:43], v[168:171], v[72:75]
    v_fma_f32 v101, v101, s28, v16
    v_add_f32 v20, v20, v100
    v_mfma_f32_16x16x32_bf16 v[72:75], v[44:47], v[172:175], v[72:75]
    v_exp_f32 v101, v101
    v_mfma_f32_16x16x32_bf16 v[80:83], v[32:35], v[192:195], 0
    v_cvt_pk_bf16_f32 v98, v100, v101
    v_add_f32 v20, v20, v101
    v_mfma_f32_16x16x32_bf16 v[80:83], v[36:39], v[196:199], v[80:83]
    v_fma_f32 v108, v108, s28, v17
    v_fma_f32 v109, v109, s28, v17
    v_mfma_f32_16x16x32_bf16 v[80:83], v[40:43], v[200:203], v[80:83]
    v_exp_f32 v108, v108
    v_mfma_f32_16x16x32_bf16 v[80:83], v[44:47], v[204:207], v[80:83]
    v_exp_f32 v109, v109
    v_mfma_f32_16x16x32_bf16 v[88:91], v[32:35], v[224:227], 0
    v_add_f32 v21, v21, v108
    v_cvt_pk_bf16_f32 v106, v108, v109
    v_mfma_f32_16x16x32_bf16 v[88:91], v[36:39], v[228:231], v[88:91]
    v_add_f32 v21, v21, v109
    v_fma_f32 v116, v116, s28, v18
    v_mfma_f32_16x16x32_bf16 v[88:91], v[40:43], v[232:235], v[88:91]
    v_exp_f32 v116, v116
    v_mfma_f32_16x16x32_bf16 v[88:91], v[44:47], v[236:239], v[88:91]
    v_fma_f32 v117, v117, s28, v18
    v_add_f32 v22, v22, v116
    s_waitcnt lgkmcnt(0)
    v_mfma_f32_16x16x32_bf16 v[64:67], v[48:51], v[144:147], v[64:67]
    ds_read_b128 v[32:35], v0 offset:40960
    v_mfma_f32_16x16x32_bf16 v[64:67], v[52:55], v[148:151], v[64:67]
    ds_read_b128 v[36:39], v1 offset:40960
    v_fma_f32 v124, v124, s28, v19
    v_mfma_f32_16x16x32_bf16 v[64:67], v[56:59], v[152:155], v[64:67]
    ds_read_b128 v[40:43], v2 offset:40960
    v_fma_f32 v125, v125, s28, v19
    v_mfma_f32_16x16x32_bf16 v[64:67], v[60:63], v[156:159], v[64:67]
    ds_read_b128 v[44:47], v3 offset:40960
    v_fma_f32 v102, v102, s28, v16
    v_mfma_f32_16x16x32_bf16 v[72:75], v[48:51], v[176:179], v[72:75]
    v_mfma_f32_16x16x32_bf16 v[72:75], v[52:55], v[180:183], v[72:75]
    v_exp_f32 v117, v117
    v_mfma_f32_16x16x32_bf16 v[72:75], v[56:59], v[184:187], v[72:75]
    v_exp_f32 v124, v124
    v_mfma_f32_16x16x32_bf16 v[72:75], v[60:63], v[188:191], v[72:75]
    v_exp_f32 v125, v125
    v_mfma_f32_16x16x32_bf16 v[80:83], v[48:51], v[208:211], v[80:83]
    v_exp_f32 v102, v102
    v_mfma_f32_16x16x32_bf16 v[80:83], v[52:55], v[212:215], v[80:83]
    v_cvt_pk_bf16_f32 v114, v116, v117
    v_add_f32 v22, v22, v117
    v_mfma_f32_16x16x32_bf16 v[80:83], v[56:59], v[216:219], v[80:83]
    v_add_f32 v23, v23, v124
    v_cvt_pk_bf16_f32 v122, v124, v125
    v_mfma_f32_16x16x32_bf16 v[80:83], v[60:63], v[220:223], v[80:83]
    v_add_f32 v23, v23, v125
    v_mfma_f32_16x16x32_bf16 v[88:91], v[48:51], v[240:243], v[88:91]
    v_mfma_f32_16x16x32_bf16 v[88:91], v[52:55], v[244:247], v[88:91]
    v_fma_f32 v103, v103, s28, v16
    v_add_f32 v20, v20, v102
    v_mfma_f32_16x16x32_bf16 v[88:91], v[56:59], v[248:251], v[88:91]
    v_exp_f32 v103, v103
    v_mfma_f32_16x16x32_bf16 v[88:91], v[60:63], v[252:255], v[88:91]
    v_cvt_pk_bf16_f32 v99, v102, v103
    v_add_f32 v20, v20, v103
    s_waitcnt lgkmcnt(0)
    v_mfma_f32_16x16x32_bf16 v[68:71], v[32:35], v[128:131], 0
    ds_read_b128 v[48:51], v0 offset:41216
    v_fma_f32 v110, v110, s28, v17
    v_mfma_f32_16x16x32_bf16 v[68:71], v[36:39], v[132:135], v[68:71]
    ds_read_b128 v[52:55], v1 offset:41216
    v_fma_f32 v111, v111, s28, v17
    v_mfma_f32_16x16x32_bf16 v[68:71], v[40:43], v[136:139], v[68:71]
    ds_read_b128 v[56:59], v2 offset:41216
    v_fma_f32 v118, v118, s28, v18
    v_mfma_f32_16x16x32_bf16 v[68:71], v[44:47], v[140:143], v[68:71]
    ds_read_b128 v[60:63], v3 offset:41216
    v_fma_f32 v119, v119, s28, v18
    v_mfma_f32_16x16x32_bf16 v[76:79], v[32:35], v[160:163], 0
    v_exp_f32 v110, v110
    v_mfma_f32_16x16x32_bf16 v[76:79], v[36:39], v[164:167], v[76:79]
    v_exp_f32 v111, v111
    v_mfma_f32_16x16x32_bf16 v[76:79], v[40:43], v[168:171], v[76:79]
    v_add_f32 v21, v21, v110
    v_mfma_f32_16x16x32_bf16 v[76:79], v[44:47], v[172:175], v[76:79]
    v_mfma_f32_16x16x32_bf16 v[84:87], v[32:35], v[192:195], 0
    v_exp_f32 v118, v118
    v_mfma_f32_16x16x32_bf16 v[84:87], v[36:39], v[196:199], v[84:87]
    v_exp_f32 v119, v119
    v_mfma_f32_16x16x32_bf16 v[84:87], v[40:43], v[200:203], v[84:87]
    v_cvt_pk_bf16_f32 v107, v110, v111
    v_add_f32 v21, v21, v111
    v_mfma_f32_16x16x32_bf16 v[84:87], v[44:47], v[204:207], v[84:87]
    v_add_f32 v22, v22, v118
    v_cvt_pk_bf16_f32 v115, v118, v119
    v_mfma_f32_16x16x32_bf16 v[92:95], v[32:35], v[224:227], 0
    v_add_f32 v22, v22, v119
    v_fma_f32 v126, v126, s28, v19
    v_mfma_f32_16x16x32_bf16 v[92:95], v[36:39], v[228:231], v[92:95]
    v_exp_f32 v126, v126
    v_mfma_f32_16x16x32_bf16 v[92:95], v[40:43], v[232:235], v[92:95]
    v_fma_f32 v127, v127, s28, v19
    v_add_f32 v23, v23, v126
    v_mfma_f32_16x16x32_bf16 v[92:95], v[44:47], v[236:239], v[92:95]
    v_exp_f32 v127, v127
    s_waitcnt lgkmcnt(0)
    v_mfma_f32_16x16x32_bf16 v[68:71], v[48:51], v[144:147], v[68:71]
    ds_read_b64_tr_b16 v[32:33], v4 offset:16384
    v_cvt_pk_bf16_f32 v123, v126, v127
    v_mfma_f32_16x16x32_bf16 v[68:71], v[52:55], v[148:151], v[68:71]
    ds_read_b64_tr_b16 v[34:35], v4 offset:24576
    v_add_f32 v23, v23, v127
    v_mfma_f32_16x16x32_bf16 v[68:71], v[56:59], v[152:155], v[68:71]
    ds_read_b64_tr_b16 v[36:37], v5 offset:16384
    v_max3_f32 v24, v64, v65, v66
    s_waitcnt vmcnt(4)
    s_barrier
    v_mfma_f32_16x16x32_bf16 v[68:71], v[60:63], v[156:159], v[68:71]
    ds_read_b64_tr_b16 v[38:39], v5 offset:24576
    v_max3_f32 v25, v72, v73, v74
    v_mfma_f32_16x16x32_bf16 v[76:79], v[48:51], v[176:179], v[76:79]
    ds_read_b64_tr_b16 v[40:41], v6 offset:16384
    v_max3_f32 v26, v80, v81, v82
    v_mfma_f32_16x16x32_bf16 v[76:79], v[52:55], v[180:183], v[76:79]
    ds_read_b64_tr_b16 v[42:43], v6 offset:24576
    v_max3_f32 v27, v88, v89, v90
    v_mfma_f32_16x16x32_bf16 v[76:79], v[56:59], v[184:187], v[76:79]
    ds_read_b64_tr_b16 v[44:45], v7 offset:16384
    v_max_f32 v24, v24, v67
    v_mfma_f32_16x16x32_bf16 v[76:79], v[60:63], v[188:191], v[76:79]
    ds_read_b64_tr_b16 v[46:47], v7 offset:24576
    v_max_f32 v25, v25, v75
    v_mfma_f32_16x16x32_bf16 v[84:87], v[48:51], v[208:211], v[84:87]
    v_max_f32 v26, v26, v83
    v_max_f32 v27, v27, v91
    v_mfma_f32_16x16x32_bf16 v[84:87], v[52:55], v[212:215], v[84:87]
    v_mfma_f32_16x16x32_bf16 v[84:87], v[56:59], v[216:219], v[84:87]
    v_mfma_f32_16x16x32_bf16 v[84:87], v[60:63], v[220:223], v[84:87]
    v_mfma_f32_16x16x32_bf16 v[92:95], v[48:51], v[240:243], v[92:95]
    v_mfma_f32_16x16x32_bf16 v[92:95], v[52:55], v[244:247], v[92:95]
    v_mfma_f32_16x16x32_bf16 v[92:95], v[56:59], v[248:251], v[92:95]
    v_mfma_f32_16x16x32_bf16 v[92:95], v[60:63], v[252:255], v[92:95]
    s_waitcnt lgkmcnt(0)
    v_mfma_f32_16x16x32_bf16 a[0:3], v[32:35], v[96:99], a[0:3]
    ds_read_b64_tr_b16 v[48:49], v8 offset:16384
    v_mfma_f32_16x16x32_bf16 a[4:7], v[36:39], v[96:99], a[4:7]
    ds_read_b64_tr_b16 v[50:51], v8 offset:24576
    v_mfma_f32_16x16x32_bf16 a[8:11], v[40:43], v[96:99], a[8:11]
    ds_read_b64_tr_b16 v[52:53], v9 offset:16384
    v_max3_f32 v24, v24, v68, v69
    v_mfma_f32_16x16x32_bf16 a[12:15], v[44:47], v[96:99], a[12:15]
    ds_read_b64_tr_b16 v[54:55], v9 offset:24576
    v_max3_f32 v25, v25, v76, v77
    v_mfma_f32_16x16x32_bf16 a[64:67], v[32:35], v[104:107], a[64:67]
    ds_read_b64_tr_b16 v[56:57], v10 offset:16384
    v_max3_f32 v26, v26, v84, v85
    v_mfma_f32_16x16x32_bf16 a[68:71], v[36:39], v[104:107], a[68:71]
    ds_read_b64_tr_b16 v[58:59], v10 offset:24576
    v_max3_f32 v27, v27, v92, v93
    v_mfma_f32_16x16x32_bf16 a[72:75], v[40:43], v[104:107], a[72:75]
    ds_read_b64_tr_b16 v[60:61], v11 offset:16384
    v_max3_f32 v24, v24, v70, v71
    v_mfma_f32_16x16x32_bf16 a[76:79], v[44:47], v[104:107], a[76:79]
    ds_read_b64_tr_b16 v[62:63], v11 offset:24576
    v_max3_f32 v25, v25, v78, v79
    v_mfma_f32_16x16x32_bf16 a[128:131], v[32:35], v[112:115], a[128:131]
    v_max3_f32 v26, v26, v86, v87
    v_max3_f32 v27, v27, v94, v95
    v_mfma_f32_16x16x32_bf16 a[132:135], v[36:39], v[112:115], a[132:135]
    v_fma_f32 v28, v24, s28, v16
    v_fma_f32 v29, v25, s28, v17
    v_mfma_f32_16x16x32_bf16 a[136:139], v[40:43], v[112:115], a[136:139]
    v_fma_f32 v30, v26, s28, v18
    v_fma_f32 v31, v27, s28, v19
    v_mfma_f32_16x16x32_bf16 a[140:143], v[44:47], v[112:115], a[140:143]
    v_max3_f32 v28, v28, v29, v30
    v_max_f32 v28, v28, v31
    v_mfma_f32_16x16x32_bf16 a[192:195], v[32:35], v[120:123], a[192:195]
    v_cmp_lt_f32 vcc, 0x41000000, v28
    s_cbranch_vccnz L_skipA_29_stub
L_skipA_29:
    v_mfma_f32_16x16x32_bf16 a[196:199], v[36:39], v[120:123], a[196:199]
    v_fma_f32 v64, v64, s28, v16
    v_fma_f32 v65, v65, s28, v16
    v_mfma_f32_16x16x32_bf16 a[200:203], v[40:43], v[120:123], a[200:203]
    v_mfma_f32_16x16x32_bf16 a[204:207], v[44:47], v[120:123], a[204:207]
    v_exp_f32 v64, v64
    s_waitcnt lgkmcnt(0)
    v_mfma_f32_16x16x32_bf16 a[16:19], v[48:51], v[96:99], a[16:19]
    ds_read_b64_tr_b16 v[32:33], v4 offset:16640
    v_add_f32 v20, v20, v64
    v_mfma_f32_16x16x32_bf16 a[20:23], v[52:55], v[96:99], a[20:23]
    ds_read_b64_tr_b16 v[34:35], v4 offset:24832
    v_fma_f32 v72, v72, s28, v17
    v_mfma_f32_16x16x32_bf16 a[24:27], v[56:59], v[96:99], a[24:27]
    ds_read_b64_tr_b16 v[36:37], v5 offset:16640
    v_fma_f32 v73, v73, s28, v17
    v_mfma_f32_16x16x32_bf16 a[28:31], v[60:63], v[96:99], a[28:31]
    ds_read_b64_tr_b16 v[38:39], v5 offset:24832
    v_fma_f32 v80, v80, s28, v18
    v_mfma_f32_16x16x32_bf16 a[80:83], v[48:51], v[104:107], a[80:83]
    ds_read_b64_tr_b16 v[40:41], v6 offset:16640
    v_fma_f32 v81, v81, s28, v18
    v_mfma_f32_16x16x32_bf16 a[84:87], v[52:55], v[104:107], a[84:87]
    ds_read_b64_tr_b16 v[42:43], v6 offset:24832
    v_fma_f32 v88, v88, s28, v19
    v_mfma_f32_16x16x32_bf16 a[88:91], v[56:59], v[104:107], a[88:91]
    ds_read_b64_tr_b16 v[44:45], v7 offset:16640
    v_fma_f32 v89, v89, s28, v19
    v_mfma_f32_16x16x32_bf16 a[92:95], v[60:63], v[104:107], a[92:95]
    ds_read_b64_tr_b16 v[46:47], v7 offset:24832
    v_fma_f32 v66, v66, s28, v16
    v_mfma_f32_16x16x32_bf16 a[144:147], v[48:51], v[112:115], a[144:147]
    v_exp_f32 v65, v65
    v_mfma_f32_16x16x32_bf16 a[148:151], v[52:55], v[112:115], a[148:151]
    v_cvt_pk_bf16_f32 v64, v64, v65
    v_mfma_f32_16x16x32_bf16 a[152:155], v[56:59], v[112:115], a[152:155]
    v_exp_f32 v72, v72
    v_mfma_f32_16x16x32_bf16 a[156:159], v[60:63], v[112:115], a[156:159]
    v_add_f32 v20, v20, v65
    v_mfma_f32_16x16x32_bf16 a[208:211], v[48:51], v[120:123], a[208:211]
    v_mfma_f32_16x16x32_bf16 a[212:215], v[52:55], v[120:123], a[212:215]
    v_exp_f32 v73, v73
    v_mfma_f32_16x16x32_bf16 a[216:219], v[56:59], v[120:123], a[216:219]
    v_exp_f32 v80, v80
    v_mfma_f32_16x16x32_bf16 a[220:223], v[60:63], v[120:123], a[220:223]
    v_exp_f32 v81, v81
    s_waitcnt lgkmcnt(0)
    v_mfma_f32_16x16x32_bf16 a[32:35], v[32:35], v[96:99], a[32:35]
    ds_read_b64_tr_b16 v[48:49], v8 offset:16640
    v_add_f32 v21, v21, v72
    v_mfma_f32_16x16x32_bf16 a[36:39], v[36:39], v[96:99], a[36:39]
    ds_read_b64_tr_b16 v[50:51], v8 offset:24832
    v_cvt_pk_bf16_f32 v72, v72, v73
    v_mfma_f32_16x16x32_bf16 a[40:43], v[40:43], v[96:99], a[40:43]
    ds_read_b64_tr_b16 v[52:53], v9 offset:16640
    v_add_f32 v21, v21, v73
    v_mfma_f32_16x16x32_bf16 a[44:47], v[44:47], v[96:99], a[44:47]
    ds_read_b64_tr_b16 v[54:55], v9 offset:24832
    v_add_f32 v22, v22, v80
    v_mfma_f32_16x16x32_bf16 a[96:99], v[32:35], v[104:107], a[96:99]
    ds_read_b64_tr_b16 v[56:57], v10 offset:16640
    v_mfma_f32_16x16x32_bf16 a[100:103], v[36:39], v[104:107], a[100:103]
    ds_read_b64_tr_b16 v[58:59], v10 offset:24832
    v_cvt_pk_bf16_f32 v80, v80, v81
    v_mfma_f32_16x16x32_bf16 a[104:107], v[40:43], v[104:107], a[104:107]
    ds_read_b64_tr_b16 v[60:61], v11 offset:16640
    v_add_f32 v22, v22, v81
    v_mfma_f32_16x16x32_bf16 a[108:111], v[44:47], v[104:107], a[108:111]
    ds_read_b64_tr_b16 v[62:63], v11 offset:24832
    v_fma_f32 v67, v67, s28, v16
    v_mfma_f32_16x16x32_bf16 a[160:163], v[32:35], v[112:115], a[160:163]
    v_fma_f32 v74, v74, s28, v17
    v_mfma_f32_16x16x32_bf16 a[164:167], v[36:39], v[112:115], a[164:167]
    v_mfma_f32_16x16x32_bf16 a[168:171], v[40:43], v[112:115], a[168:171]
    v_exp_f32 v88, v88
    v_mfma_f32_16x16x32_bf16 a[172:175], v[44:47], v[112:115], a[172:175]
    v_exp_f32 v89, v89
    v_mfma_f32_16x16x32_bf16 a[224:227], v[32:35], v[120:123], a[224:227]
    v_exp_f32 v66, v66
    v_mfma_f32_16x16x32_bf16 a[228:231], v[36:39], v[120:123], a[228:231]
    v_exp_f32 v67, v67
    v_mfma_f32_16x16x32_bf16 a[232:235], v[40:43], v[120:123], a[232:235]
    v_exp_f32 v74, v74
    v_mfma_f32_16x16x32_bf16 a[236:239], v[44:47], v[120:123], a[236:239]
    v_add_f32 v23, v23, v88
    v_cvt_pk_bf16_f32 v88, v88, v89
    s_waitcnt lgkmcnt(0)
    v_mfma_f32_16x16x32_bf16 a[48:51], v[48:51], v[96:99], a[48:51]
    ds_read_b128 v[32:35], v0 offset:49152
    v_add_f32 v23, v23, v89
    v_mfma_f32_16x16x32_bf16 a[52:55], v[52:55], v[96:99], a[52:55]
    ds_read_b128 v[36:39], v1 offset:49152
    v_add_f32 v20, v20, v66
    v_mfma_f32_16x16x32_bf16 a[56:59], v[56:59], v[96:99], a[56:59]
    ds_read_b128 v[40:43], v2 offset:49152
    v_cvt_pk_bf16_f32 v65, v66, v67
    v_mfma_f32_16x16x32_bf16 a[60:63], v[60:63], v[96:99], a[60:63]
    ds_read_b128 v[44:47], v3 offset:49152
    v_add_f32 v20, v20, v67
    v_mfma_f32_16x16x32_bf16 a[112:115], v[48:51], v[104:107], a[112:115]
    v_fma_f32 v75, v75, s28, v17
    v_add_f32 v21, v21, v74
    v_mfma_f32_16x16x32_bf16 a[116:119], v[52:55], v[104:107], a[116:119]
    v_fma_f32 v82, v82, s28, v18
    v_mfma_f32_16x16x32_bf16 a[120:123], v[56:59], v[104:107], a[120:123]
    v_mfma_f32_16x16x32_bf16 a[124:127], v[60:63], v[104:107], a[124:127]
    v_exp_f32 v75, v75
    v_mfma_f32_16x16x32_bf16 a[176:179], v[48:51], v[112:115], a[176:179]
    v_exp_f32 v82, v82
    v_mfma_f32_16x16x32_bf16 a[180:183], v[52:55], v[112:115], a[180:183]
    v_cvt_pk_bf16_f32 v73, v74, v75
    v_add_f32 v21, v21, v75
    v_mfma_f32_16x16x32_bf16 a[184:187], v[56:59], v[112:115], a[184:187]
    v_fma_f32 v83, v83, s28, v18
    v_add_f32 v22, v22, v82
    v_mfma_f32_16x16x32_bf16 a[188:191], v[60:63], v[112:115], a[188:191]
    v_exp_f32 v83, v83
    v_mfma_f32_16x16x32_bf16 a[240:243], v[48:51], v[120:123], a[240:243]
    v_cvt_pk_bf16_f32 v81, v82, v83
    v_add_f32 v22, v22, v83
    v_mfma_f32_16x16x32_bf16 a[244:247], v[52:55], v[120:123], a[244:247]
    v_fma_f32 v90, v90, s28, v19
    v_fma_f32 v91, v91, s28, v19
    v_mfma_f32_16x16x32_bf16 a[248:251], v[56:59], v[120:123], a[248:251]
    v_exp_f32 v90, v90
    v_mfma_f32_16x16x32_bf16 a[252:255], v[60:63], v[120:123], a[252:255]
    v_exp_f32 v91, v91
    s_cmp_eq_u32 s33, 0
    s_cbranch_scc0 L_skipB_29_stub
L_skipB_29:
    s_waitcnt lgkmcnt(0)
    v_mfma_f32_16x16x32_bf16 v[96:99], v[32:35], v[128:131], 0
    ds_read_b128 v[48:51], v0 offset:49408
    v_add_f32 v23, v23, v90
    v_mfma_f32_16x16x32_bf16 v[96:99], v[36:39], v[132:135], v[96:99]
    ds_read_b128 v[52:55], v1 offset:49408
    v_cvt_pk_bf16_f32 v89, v90, v91
    v_mfma_f32_16x16x32_bf16 v[96:99], v[40:43], v[136:139], v[96:99]
    ds_read_b128 v[56:59], v2 offset:49408
    v_add_f32 v23, v23, v91
    v_mfma_f32_16x16x32_bf16 v[96:99], v[44:47], v[140:143], v[96:99]
    ds_read_b128 v[60:63], v3 offset:49408
    v_fma_f32 v68, v68, s28, v16
    v_mfma_f32_16x16x32_bf16 v[104:107], v[32:35], v[160:163], 0
    v_exp_f32 v68, v68
    v_mfma_f32_16x16x32_bf16 v[104:107], v[36:39], v[164:167], v[104:107]
    v_mfma_f32_16x16x32_bf16 v[104:107], v[40:43], v[168:171], v[104:107]
    v_fma_f32 v69, v69, s28, v16
    v_add_f32 v20, v20, v68
    v_mfma_f32_16x16x32_bf16 v[104:107], v[44:47], v[172:175], v[104:107]
    v_exp_f32 v69, v69
    v_mfma_f32_16x16x32_bf16 v[112:115], v[32:35], v[192:195], 0
    v_cvt_pk_bf16_f32 v66, v68, v69
    v_add_f32 v20, v20, v69
    v_mfma_f32_16x16x32_bf16 v[112:115], v[36:39], v[196:199], v[112:115]
    v_fma_f32 v76, v76, s28, v17
    v_fma_f32 v77, v77, s28, v17
    v_mfma_f32_16x16x32_bf16 v[112:115], v[40:43], v[200:203], v[112:115]
    v_exp_f32 v76, v76
    v_mfma_f32_16x16x32_bf16 v[112:115], v[44:47], v[204:207], v[112:115]
    v_exp_f32 v77, v77
    v_mfma_f32_16x16x32_bf16 v[120:123], v[32:35], v[224:227], 0
    v_add_f32 v21, v21, v76
    v_cvt_pk_bf16_f32 v74, v76, v77
    v_mfma_f32_16x16x32_bf16 v[120:123], v[36:39], v[228:231], v[120:123]
    v_add_f32 v21, v21, v77
    v_fma_f32 v84, v84, s28, v18
    v_mfma_f32_16x16x32_bf16 v[120:123], v[40:43], v[232:235], v[120:123]
    v_exp_f32 v84, v84
    v_mfma_f32_16x16x32_bf16 v[120:123], v[44:47], v[236:239], v[120:123]
    v_fma_f32 v85, v85, s28, v18
    v_add_f32 v22, v22, v84
    s_waitcnt lgkmcnt(0)
    v_mfma_f32_16x16x32_bf16 v[96:99], v[48:51], v[144:147], v[96:99]
    ds_read_b128 v[32:35], v0 offset:57344
    v_mfma_f32_16x16x32_bf16 v[96:99], v[52:55], v[148:151], v[96:99]
    ds_read_b128 v[36:39], v1 offset:57344
    v_fma_f32 v92, v92, s28, v19
    v_mfma_f32_16x16x32_bf16 v[96:99], v[56:59], v[152:155], v[96:99]
    ds_read_b128 v[40:43], v2 offset:57344
    v_fma_f32 v93, v93, s28, v19
    v_mfma_f32_16x16x32_bf16 v[96:99], v[60:63], v[156:159], v[96:99]
    ds_read_b128 v[44:47], v3 offset:57344
    v_fma_f32 v70, v70, s28, v16
    v_mfma_f32_16x16x32_bf16 v[104:107], v[48:51], v[176:179], v[104:107]
    v_mfma_f32_16x16x32_bf16 v[104:107], v[52:55], v[180:183], v[104:107]
    v_exp_f32 v85, v85
    v_mfma_f32_16x16x32_bf16 v[104:107], v[56:59], v[184:187], v[104:107]
    v_exp_f32 v92, v92
    v_mfma_f32_16x16x32_bf16 v[104:107], v[60:63], v[188:191], v[104:107]
    v_exp_f32 v93, v93
    v_mfma_f32_16x16x32_bf16 v[112:115], v[48:51], v[208:211], v[112:115]
    v_exp_f32 v70, v70
    v_mfma_f32_16x16x32_bf16 v[112:115], v[52:55], v[212:215], v[112:115]
    v_cvt_pk_bf16_f32 v82, v84, v85
    v_add_f32 v22, v22, v85
    v_mfma_f32_16x16x32_bf16 v[112:115], v[56:59], v[216:219], v[112:115]
    v_add_f32 v23, v23, v92
    v_cvt_pk_bf16_f32 v90, v92, v93
    v_mfma_f32_16x16x32_bf16 v[112:115], v[60:63], v[220:223], v[112:115]
    v_add_f32 v23, v23, v93
    v_mfma_f32_16x16x32_bf16 v[120:123], v[48:51], v[240:243], v[120:123]
    v_mfma_f32_16x16x32_bf16 v[120:123], v[52:55], v[244:247], v[120:123]
    v_fma_f32 v71, v71, s28, v16
    v_add_f32 v20, v20, v70
    v_mfma_f32_16x16x32_bf16 v[120:123], v[56:59], v[248:251], v[120:123]
    v_exp_f32 v71, v71
    v_mfma_f32_16x16x32_bf16 v[120:123], v[60:63], v[252:255], v[120:123]
    v_cvt_pk_bf16_f32 v67, v70, v71
    v_add_f32 v20, v20, v71
    s_waitcnt lgkmcnt(0)
    v_mfma_f32_16x16x32_bf16 v[100:103], v[32:35], v[128:131], 0
    ds_read_b128 v[48:51], v0 offset:57600
    v_fma_f32 v78, v78, s28, v17
    v_mfma_f32_16x16x32_bf16 v[100:103], v[36:39], v[132:135], v[100:103]
    ds_read_b128 v[52:55], v1 offset:57600
    v_fma_f32 v79, v79, s28, v17
    v_mfma_f32_16x16x32_bf16 v[100:103], v[40:43], v[136:139], v[100:103]
    ds_read_b128 v[56:59], v2 offset:57600
    v_fma_f32 v86, v86, s28, v18
    v_mfma_f32_16x16x32_bf16 v[100:103], v[44:47], v[140:143], v[100:103]
    ds_read_b128 v[60:63], v3 offset:57600
    v_fma_f32 v87, v87, s28, v18
    v_mfma_f32_16x16x32_bf16 v[108:111], v[32:35], v[160:163], 0
    v_exp_f32 v78, v78
    v_mfma_f32_16x16x32_bf16 v[108:111], v[36:39], v[164:167], v[108:111]
    v_exp_f32 v79, v79
    v_mfma_f32_16x16x32_bf16 v[108:111], v[40:43], v[168:171], v[108:111]
    v_add_f32 v21, v21, v78
    v_mfma_f32_16x16x32_bf16 v[108:111], v[44:47], v[172:175], v[108:111]
    v_mfma_f32_16x16x32_bf16 v[116:119], v[32:35], v[192:195], 0
    v_exp_f32 v86, v86
    v_mfma_f32_16x16x32_bf16 v[116:119], v[36:39], v[196:199], v[116:119]
    v_exp_f32 v87, v87
    v_mfma_f32_16x16x32_bf16 v[116:119], v[40:43], v[200:203], v[116:119]
    v_cvt_pk_bf16_f32 v75, v78, v79
    v_add_f32 v21, v21, v79
    v_mfma_f32_16x16x32_bf16 v[116:119], v[44:47], v[204:207], v[116:119]
    v_add_f32 v22, v22, v86
    v_cvt_pk_bf16_f32 v83, v86, v87
    v_mfma_f32_16x16x32_bf16 v[124:127], v[32:35], v[224:227], 0
    v_add_f32 v22, v22, v87
    v_fma_f32 v94, v94, s28, v19
    v_mfma_f32_16x16x32_bf16 v[124:127], v[36:39], v[228:231], v[124:127]
    v_exp_f32 v94, v94
    v_mfma_f32_16x16x32_bf16 v[124:127], v[40:43], v[232:235], v[124:127]
    v_fma_f32 v95, v95, s28, v19
    v_add_f32 v23, v23, v94
    v_mfma_f32_16x16x32_bf16 v[124:127], v[44:47], v[236:239], v[124:127]
    v_exp_f32 v95, v95
    s_waitcnt lgkmcnt(0)
    v_mfma_f32_16x16x32_bf16 v[100:103], v[48:51], v[144:147], v[100:103]
    ds_read_b64_tr_b16 v[32:33], v4 offset:32768
    v_cvt_pk_bf16_f32 v91, v94, v95
    v_mfma_f32_16x16x32_bf16 v[100:103], v[52:55], v[148:151], v[100:103]
    ds_read_b64_tr_b16 v[34:35], v4 offset:40960
    v_add_f32 v23, v23, v95
    v_mfma_f32_16x16x32_bf16 v[100:103], v[56:59], v[152:155], v[100:103]
    ds_read_b64_tr_b16 v[36:37], v5 offset:32768
    v_max3_f32 v24, v96, v97, v98
    s_waitcnt vmcnt(0)
    s_barrier
    v_mfma_f32_16x16x32_bf16 v[100:103], v[60:63], v[156:159], v[100:103]
    ds_read_b64_tr_b16 v[38:39], v5 offset:40960
    v_max3_f32 v25, v104, v105, v106
    v_mfma_f32_16x16x32_bf16 v[108:111], v[48:51], v[176:179], v[108:111]
    ds_read_b64_tr_b16 v[40:41], v6 offset:32768
    v_max3_f32 v26, v112, v113, v114
    v_mfma_f32_16x16x32_bf16 v[108:111], v[52:55], v[180:183], v[108:111]
    ds_read_b64_tr_b16 v[42:43], v6 offset:40960
    v_max3_f32 v27, v120, v121, v122
    v_mfma_f32_16x16x32_bf16 v[108:111], v[56:59], v[184:187], v[108:111]
    ds_read_b64_tr_b16 v[44:45], v7 offset:32768
    v_max_f32 v24, v24, v99
    v_mfma_f32_16x16x32_bf16 v[108:111], v[60:63], v[188:191], v[108:111]
    ds_read_b64_tr_b16 v[46:47], v7 offset:40960
    v_max_f32 v25, v25, v107
    v_mfma_f32_16x16x32_bf16 v[116:119], v[48:51], v[208:211], v[116:119]
    v_max_f32 v26, v26, v115
    v_max_f32 v27, v27, v123
    v_mfma_f32_16x16x32_bf16 v[116:119], v[52:55], v[212:215], v[116:119]
    v_mfma_f32_16x16x32_bf16 v[116:119], v[56:59], v[216:219], v[116:119]
    v_mfma_f32_16x16x32_bf16 v[116:119], v[60:63], v[220:223], v[116:119]
    v_mfma_f32_16x16x32_bf16 v[124:127], v[48:51], v[240:243], v[124:127]
    v_mfma_f32_16x16x32_bf16 v[124:127], v[52:55], v[244:247], v[124:127]
    v_mfma_f32_16x16x32_bf16 v[124:127], v[56:59], v[248:251], v[124:127]
    v_mfma_f32_16x16x32_bf16 v[124:127], v[60:63], v[252:255], v[124:127]
    s_waitcnt lgkmcnt(0)
    v_mfma_f32_16x16x32_bf16 a[0:3], v[32:35], v[64:67], a[0:3]
    ds_read_b64_tr_b16 v[48:49], v8 offset:32768
    v_mfma_f32_16x16x32_bf16 a[4:7], v[36:39], v[64:67], a[4:7]
    ds_read_b64_tr_b16 v[50:51], v8 offset:40960
    v_mfma_f32_16x16x32_bf16 a[8:11], v[40:43], v[64:67], a[8:11]
    ds_read_b64_tr_b16 v[52:53], v9 offset:32768
    v_max3_f32 v24, v24, v100, v101
    v_mfma_f32_16x16x32_bf16 a[12:15], v[44:47], v[64:67], a[12:15]
    ds_read_b64_tr_b16 v[54:55], v9 offset:40960
    v_max3_f32 v25, v25, v108, v109
    v_mfma_f32_16x16x32_bf16 a[64:67], v[32:35], v[72:75], a[64:67]
    ds_read_b64_tr_b16 v[56:57], v10 offset:32768
    v_max3_f32 v26, v26, v116, v117
    v_mfma_f32_16x16x32_bf16 a[68:71], v[36:39], v[72:75], a[68:71]
    ds_read_b64_tr_b16 v[58:59], v10 offset:40960
    v_max3_f32 v27, v27, v124, v125
    v_mfma_f32_16x16x32_bf16 a[72:75], v[40:43], v[72:75], a[72:75]
    ds_read_b64_tr_b16 v[60:61], v11 offset:32768
    v_max3_f32 v24, v24, v102, v103
    v_mfma_f32_16x16x32_bf16 a[76:79], v[44:47], v[72:75], a[76:79]
    ds_read_b64_tr_b16 v[62:63], v11 offset:40960
    v_max3_f32 v25, v25, v110, v111
    v_mfma_f32_16x16x32_bf16 a[128:131], v[32:35], v[80:83], a[128:131]
    v_max3_f32 v26, v26, v118, v119
    v_max3_f32 v27, v27, v126, v127
    v_mfma_f32_16x16x32_bf16 a[132:135], v[36:39], v[80:83], a[132:135]
    v_fma_f32 v28, v24, s28, v16
    v_fma_f32 v29, v25, s28, v17
    v_mfma_f32_16x16x32_bf16 a[136:139], v[40:43], v[80:83], a[136:139]
    v_fma_f32 v30, v26, s28, v18
    v_fma_f32 v31, v27, s28, v19
    v_mfma_f32_16x16x32_bf16 a[140:143], v[44:47], v[80:83], a[140:143]
    v_max3_f32 v28, v28, v29, v30
    v_max_f32 v28, v28, v31
    v_mfma_f32_16x16x32_bf16 a[192:195], v[32:35], v[88:91], a[192:195]
    v_cmp_lt_f32 vcc, 0x41000000, v28
    s_cbranch_vccnz L_skipA_30_stub
L_skipA_30:
    v_mfma_f32_16x16x32_bf16 a[196:199], v[36:39], v[88:91], a[196:199]
    v_fma_f32 v96, v96, s28, v16
    v_fma_f32 v97, v97, s28, v16
    v_mfma_f32_16x16x32_bf16 a[200:203], v[40:43], v[88:91], a[200:203]
    v_mfma_f32_16x16x32_bf16 a[204:207], v[44:47], v[88:91], a[204:207]
    v_exp_f32 v96, v96
    s_waitcnt lgkmcnt(0)
    v_mfma_f32_16x16x32_bf16 a[16:19], v[48:51], v[64:67], a[16:19]
    ds_read_b64_tr_b16 v[32:33], v4 offset:33024
    v_add_f32 v20, v20, v96
    v_mfma_f32_16x16x32_bf16 a[20:23], v[52:55], v[64:67], a[20:23]
    ds_read_b64_tr_b16 v[34:35], v4 offset:41216
    v_fma_f32 v104, v104, s28, v17
    v_mfma_f32_16x16x32_bf16 a[24:27], v[56:59], v[64:67], a[24:27]
    ds_read_b64_tr_b16 v[36:37], v5 offset:33024
    v_fma_f32 v105, v105, s28, v17
    v_mfma_f32_16x16x32_bf16 a[28:31], v[60:63], v[64:67], a[28:31]
    ds_read_b64_tr_b16 v[38:39], v5 offset:41216
    v_fma_f32 v112, v112, s28, v18
    v_mfma_f32_16x16x32_bf16 a[80:83], v[48:51], v[72:75], a[80:83]
    ds_read_b64_tr_b16 v[40:41], v6 offset:33024
    v_fma_f32 v113, v113, s28, v18
    v_mfma_f32_16x16x32_bf16 a[84:87], v[52:55], v[72:75], a[84:87]
    ds_read_b64_tr_b16 v[42:43], v6 offset:41216
    v_fma_f32 v120, v120, s28, v19
    v_mfma_f32_16x16x32_bf16 a[88:91], v[56:59], v[72:75], a[88:91]
    ds_read_b64_tr_b16 v[44:45], v7 offset:33024
    v_fma_f32 v121, v121, s28, v19
    v_mfma_f32_16x16x32_bf16 a[92:95], v[60:63], v[72:75], a[92:95]
    ds_read_b64_tr_b16 v[46:47], v7 offset:41216
    v_fma_f32 v98, v98, s28, v16
    v_mfma_f32_16x16x32_bf16 a[144:147], v[48:51], v[80:83], a[144:147]
    v_exp_f32 v97, v97
    v_mfma_f32_16x16x32_bf16 a[148:151], v[52:55], v[80:83], a[148:151]
    v_cvt_pk_bf16_f32 v96, v96, v97
    v_mfma_f32_16x16x32_bf16 a[152:155], v[56:59], v[80:83], a[152:155]
    v_exp_f32 v104, v104
    v_mfma_f32_16x16x32_bf16 a[156:159], v[60:63], v[80:83], a[156:159]
    v_add_f32 v20, v20, v97
    v_mfma_f32_16x16x32_bf16 a[208:211], v[48:51], v[88:91], a[208:211]
    v_mfma_f32_16x16x32_bf16 a[212:215], v[52:55], v[88:91], a[212:215]
    v_exp_f32 v105, v105
    v_mfma_f32_16x16x32_bf16 a[216:219], v[56:59], v[88:91], a[216:219]
    v_exp_f32 v112, v112
    v_mfma_f32_16x16x32_bf16 a[220:223], v[60:63], v[88:91], a[220:223]
    v_exp_f32 v113, v113
    s_waitcnt lgkmcnt(0)
    v_mfma_f32_16x16x32_bf16 a[32:35], v[32:35], v[64:67], a[32:35]
    ds_read_b64_tr_b16 v[48:49], v8 offset:33024
    v_add_f32 v21, v21, v104
    v_mfma_f32_16x16x32_bf16 a[36:39], v[36:39], v[64:67], a[36:39]
    ds_read_b64_tr_b16 v[50:51], v8 offset:41216
    v_cvt_pk_bf16_f32 v104, v104, v105
    v_mfma_f32_16x16x32_bf16 a[40:43], v[40:43], v[64:67], a[40:43]
    ds_read_b64_tr_b16 v[52:53], v9 offset:33024
    v_add_f32 v21, v21, v105
    v_mfma_f32_16x16x32_bf16 a[44:47], v[44:47], v[64:67], a[44:47]
    ds_read_b64_tr_b16 v[54:55], v9 offset:41216
    v_add_f32 v22, v22, v112
    v_mfma_f32_16x16x32_bf16 a[96:99], v[32:35], v[72:75], a[96:99]
    ds_read_b64_tr_b16 v[56:57], v10 offset:33024
    v_mfma_f32_16x16x32_bf16 a[100:103], v[36:39], v[72:75], a[100:103]
    ds_read_b64_tr_b16 v[58:59], v10 offset:41216
    v_cvt_pk_bf16_f32 v112, v112, v113
    v_mfma_f32_16x16x32_bf16 a[104:107], v[40:43], v[72:75], a[104:107]
    ds_read_b64_tr_b16 v[60:61], v11 offset:33024
    v_add_f32 v22, v22, v113
    v_mfma_f32_16x16x32_bf16 a[108:111], v[44:47], v[72:75], a[108:111]
    ds_read_b64_tr_b16 v[62:63], v11 offset:41216
    v_fma_f32 v99, v99, s28, v16
    v_mfma_f32_16x16x32_bf16 a[160:163], v[32:35], v[80:83], a[160:163]
    v_fma_f32 v106, v106, s28, v17
    v_mfma_f32_16x16x32_bf16 a[164:167], v[36:39], v[80:83], a[164:167]
    v_mfma_f32_16x16x32_bf16 a[168:171], v[40:43], v[80:83], a[168:171]
    v_exp_f32 v120, v120
    v_mfma_f32_16x16x32_bf16 a[172:175], v[44:47], v[80:83], a[172:175]
    v_exp_f32 v121, v121
    v_mfma_f32_16x16x32_bf16 a[224:227], v[32:35], v[88:91], a[224:227]
    v_exp_f32 v98, v98
    v_mfma_f32_16x16x32_bf16 a[228:231], v[36:39], v[88:91], a[228:231]
    v_exp_f32 v99, v99
    v_mfma_f32_16x16x32_bf16 a[232:235], v[40:43], v[88:91], a[232:235]
    v_exp_f32 v106, v106
    v_mfma_f32_16x16x32_bf16 a[236:239], v[44:47], v[88:91], a[236:239]
    v_add_f32 v23, v23, v120
    v_cvt_pk_bf16_f32 v120, v120, v121
    s_waitcnt lgkmcnt(0)
    v_mfma_f32_16x16x32_bf16 a[48:51], v[48:51], v[64:67], a[48:51]
    v_add_f32 v23, v23, v121
    v_mfma_f32_16x16x32_bf16 a[52:55], v[52:55], v[64:67], a[52:55]
    v_add_f32 v20, v20, v98
    v_mfma_f32_16x16x32_bf16 a[56:59], v[56:59], v[64:67], a[56:59]
    v_cvt_pk_bf16_f32 v97, v98, v99
    v_mfma_f32_16x16x32_bf16 a[60:63], v[60:63], v[64:67], a[60:63]
    v_add_f32 v20, v20, v99
    v_mfma_f32_16x16x32_bf16 a[112:115], v[48:51], v[72:75], a[112:115]
    v_fma_f32 v107, v107, s28, v17
    v_add_f32 v21, v21, v106
    v_mfma_f32_16x16x32_bf16 a[116:119], v[52:55], v[72:75], a[116:119]
    v_fma_f32 v114, v114, s28, v18
    v_mfma_f32_16x16x32_bf16 a[120:123], v[56:59], v[72:75], a[120:123]
    v_mfma_f32_16x16x32_bf16 a[124:127], v[60:63], v[72:75], a[124:127]
    v_exp_f32 v107, v107
    v_mfma_f32_16x16x32_bf16 a[176:179], v[48:51], v[80:83], a[176:179]
    v_exp_f32 v114, v114
    v_mfma_f32_16x16x32_bf16 a[180:183], v[52:55], v[80:83], a[180:183]
    v_cvt_pk_bf16_f32 v105, v106, v107
    v_add_f32 v21, v21, v107
    v_mfma_f32_16x16x32_bf16 a[184:187], v[56:59], v[80:83], a[184:187]
    v_fma_f32 v115, v115, s28, v18
    v_add_f32 v22, v22, v114
    v_mfma_f32_16x16x32_bf16 a[188:191], v[60:63], v[80:83], a[188:191]
    v_exp_f32 v115, v115
    v_mfma_f32_16x16x32_bf16 a[240:243], v[48:51], v[88:91], a[240:243]
    v_cvt_pk_bf16_f32 v113, v114, v115
    v_add_f32 v22, v22, v115
    v_mfma_f32_16x16x32_bf16 a[244:247], v[52:55], v[88:91], a[244:247]
    v_fma_f32 v122, v122, s28, v19
    v_fma_f32 v123, v123, s28, v19
    v_mfma_f32_16x16x32_bf16 a[248:251], v[56:59], v[88:91], a[248:251]
    v_exp_f32 v122, v122
    v_mfma_f32_16x16x32_bf16 a[252:255], v[60:63], v[88:91], a[252:255]
    v_exp_f32 v123, v123
    s_cmp_eq_u32 s33, 0
    s_cbranch_scc0 L_skipB_30_stub
L_skipB_30:
    v_add_f32 v23, v23, v122
    v_cvt_pk_bf16_f32 v121, v122, v123
    v_add_f32 v23, v23, v123
    v_fma_f32 v100, v100, s28, v16
    v_exp_f32 v100, v100
    s_nop 0
    v_fma_f32 v101, v101, s28, v16
    v_add_f32 v20, v20, v100
    v_exp_f32 v101, v101
    s_nop 0
    v_cvt_pk_bf16_f32 v98, v100, v101
    v_add_f32 v20, v20, v101
    v_fma_f32 v108, v108, s28, v17
    v_fma_f32 v109, v109, s28, v17
    v_exp_f32 v108, v108
    s_nop 0
    v_exp_f32 v109, v109
    s_nop 0
    v_add_f32 v21, v21, v108
    v_cvt_pk_bf16_f32 v106, v108, v109
    v_add_f32 v21, v21, v109
    v_fma_f32 v116, v116, s28, v18
    v_exp_f32 v116, v116
    s_nop 0
    v_fma_f32 v117, v117, s28, v18
    v_add_f32 v22, v22, v116
    v_fma_f32 v124, v124, s28, v19
    v_fma_f32 v125, v125, s28, v19
    v_fma_f32 v102, v102, s28, v16
    v_exp_f32 v117, v117
    s_nop 0
    v_exp_f32 v124, v124
    s_nop 0
    v_exp_f32 v125, v125
    s_nop 0
    v_exp_f32 v102, v102
    s_nop 0
    v_cvt_pk_bf16_f32 v114, v116, v117
    v_add_f32 v22, v22, v117
    v_add_f32 v23, v23, v124
    v_cvt_pk_bf16_f32 v122, v124, v125
    v_add_f32 v23, v23, v125
    v_fma_f32 v103, v103, s28, v16
    v_add_f32 v20, v20, v102
    v_exp_f32 v103, v103
    s_nop 0
    v_cvt_pk_bf16_f32 v99, v102, v103
    v_add_f32 v20, v20, v103
    v_fma_f32 v110, v110, s28, v17
    v_fma_f32 v111, v111, s28, v17
    v_fma_f32 v118, v118, s28, v18
    v_fma_f32 v119, v119, s28, v18
    v_exp_f32 v110, v110
    s_nop 0
    v_exp_f32 v111, v111
    s_nop 0
    v_add_f32 v21, v21, v110
    v_exp_f32 v118, v118
    s_nop 0
    v_exp_f32 v119, v119
    s_nop 0
    v_cvt_pk_bf16_f32 v107, v110, v111
    v_add_f32 v21, v21, v111
    v_add_f32 v22, v22, v118
    v_cvt_pk_bf16_f32 v115, v118, v119
    v_add_f32 v22, v22, v119
    v_fma_f32 v126, v126, s28, v19
    v_exp_f32 v126, v126
    s_nop 0
    v_fma_f32 v127, v127, s28, v19
    v_add_f32 v23, v23, v126
    v_exp_f32 v127, v127
    s_nop 0
    ds_read_b64_tr_b16 v[32:33], v4 offset:49152
    v_cvt_pk_bf16_f32 v123, v126, v127
    ds_read_b64_tr_b16 v[34:35], v4 offset:57344
    v_add_f32 v23, v23, v127
    ds_read_b64_tr_b16 v[36:37], v5 offset:49152
    ds_read_b64_tr_b16 v[38:39], v5 offset:57344
    ds_read_b64_tr_b16 v[40:41], v6 offset:49152
    ds_read_b64_tr_b16 v[42:43], v6 offset:57344
    ds_read_b64_tr_b16 v[44:45], v7 offset:49152
    ds_read_b64_tr_b16 v[46:47], v7 offset:57344
    s_nop 1
    s_waitcnt lgkmcnt(0)
    v_mfma_f32_16x16x32_bf16 a[0:3], v[32:35], v[96:99], a[0:3]
    ds_read_b64_tr_b16 v[48:49], v8 offset:49152
    v_mfma_f32_16x16x32_bf16 a[4:7], v[36:39], v[96:99], a[4:7]
    ds_read_b64_tr_b16 v[50:51], v8 offset:57344
    v_mfma_f32_16x16x32_bf16 a[8:11], v[40:43], v[96:99], a[8:11]
    ds_read_b64_tr_b16 v[52:53], v9 offset:49152
    v_mfma_f32_16x16x32_bf16 a[12:15], v[44:47], v[96:99], a[12:15]
    ds_read_b64_tr_b16 v[54:55], v9 offset:57344
    v_mfma_f32_16x16x32_bf16 a[64:67], v[32:35], v[104:107], a[64:67]
    ds_read_b64_tr_b16 v[56:57], v10 offset:49152
    v_mfma_f32_16x16x32_bf16 a[68:71], v[36:39], v[104:107], a[68:71]
    ds_read_b64_tr_b16 v[58:59], v10 offset:57344
    v_mfma_f32_16x16x32_bf16 a[72:75], v[40:43], v[104:107], a[72:75]
    ds_read_b64_tr_b16 v[60:61], v11 offset:49152
    v_mfma_f32_16x16x32_bf16 a[76:79], v[44:47], v[104:107], a[76:79]
    ds_read_b64_tr_b16 v[62:63], v11 offset:57344
    v_mfma_f32_16x16x32_bf16 a[128:131], v[32:35], v[112:115], a[128:131]
    v_mfma_f32_16x16x32_bf16 a[132:135], v[36:39], v[112:115], a[132:135]
    v_mfma_f32_16x16x32_bf16 a[136:139], v[40:43], v[112:115], a[136:139]
    v_mfma_f32_16x16x32_bf16 a[140:143], v[44:47], v[112:115], a[140:143]
    v_mfma_f32_16x16x32_bf16 a[192:195], v[32:35], v[120:123], a[192:195]
    v_mfma_f32_16x16x32_bf16 a[196:199], v[36:39], v[120:123], a[196:199]
    v_mfma_f32_16x16x32_bf16 a[200:203], v[40:43], v[120:123], a[200:203]
    v_mfma_f32_16x16x32_bf16 a[204:207], v[44:47], v[120:123], a[204:207]
    s_waitcnt lgkmcnt(0)
    v_mfma_f32_16x16x32_bf16 a[16:19], v[48:51], v[96:99], a[16:19]
    ds_read_b64_tr_b16 v[32:33], v4 offset:49408
    v_mfma_f32_16x16x32_bf16 a[20:23], v[52:55], v[96:99], a[20:23]
    ds_read_b64_tr_b16 v[34:35], v4 offset:57600
    v_mfma_f32_16x16x32_bf16 a[24:27], v[56:59], v[96:99], a[24:27]
    ds_read_b64_tr_b16 v[36:37], v5 offset:49408
    v_mfma_f32_16x16x32_bf16 a[28:31], v[60:63], v[96:99], a[28:31]
    ds_read_b64_tr_b16 v[38:39], v5 offset:57600
    v_mfma_f32_16x16x32_bf16 a[80:83], v[48:51], v[104:107], a[80:83]
    ds_read_b64_tr_b16 v[40:41], v6 offset:49408
    v_mfma_f32_16x16x32_bf16 a[84:87], v[52:55], v[104:107], a[84:87]
    ds_read_b64_tr_b16 v[42:43], v6 offset:57600
    v_mfma_f32_16x16x32_bf16 a[88:91], v[56:59], v[104:107], a[88:91]
    ds_read_b64_tr_b16 v[44:45], v7 offset:49408
    v_mfma_f32_16x16x32_bf16 a[92:95], v[60:63], v[104:107], a[92:95]
    ds_read_b64_tr_b16 v[46:47], v7 offset:57600
    v_mfma_f32_16x16x32_bf16 a[144:147], v[48:51], v[112:115], a[144:147]
    v_mfma_f32_16x16x32_bf16 a[148:151], v[52:55], v[112:115], a[148:151]
    v_mfma_f32_16x16x32_bf16 a[152:155], v[56:59], v[112:115], a[152:155]
    v_mfma_f32_16x16x32_bf16 a[156:159], v[60:63], v[112:115], a[156:159]
    v_mfma_f32_16x16x32_bf16 a[208:211], v[48:51], v[120:123], a[208:211]
    v_mfma_f32_16x16x32_bf16 a[212:215], v[52:55], v[120:123], a[212:215]
    v_mfma_f32_16x16x32_bf16 a[216:219], v[56:59], v[120:123], a[216:219]
    v_mfma_f32_16x16x32_bf16 a[220:223], v[60:63], v[120:123], a[220:223]
    s_waitcnt lgkmcnt(0)
    v_mfma_f32_16x16x32_bf16 a[32:35], v[32:35], v[96:99], a[32:35]
    ds_read_b64_tr_b16 v[48:49], v8 offset:49408
    v_mfma_f32_16x16x32_bf16 a[36:39], v[36:39], v[96:99], a[36:39]
    ds_read_b64_tr_b16 v[50:51], v8 offset:57600
    v_mfma_f32_16x16x32_bf16 a[40:43], v[40:43], v[96:99], a[40:43]
    ds_read_b64_tr_b16 v[52:53], v9 offset:49408
    v_mfma_f32_16x16x32_bf16 a[44:47], v[44:47], v[96:99], a[44:47]
    ds_read_b64_tr_b16 v[54:55], v9 offset:57600
    v_mfma_f32_16x16x32_bf16 a[96:99], v[32:35], v[104:107], a[96:99]
    ds_read_b64_tr_b16 v[56:57], v10 offset:49408
    v_mfma_f32_16x16x32_bf16 a[100:103], v[36:39], v[104:107], a[100:103]
    ds_read_b64_tr_b16 v[58:59], v10 offset:57600
    v_mfma_f32_16x16x32_bf16 a[104:107], v[40:43], v[104:107], a[104:107]
    ds_read_b64_tr_b16 v[60:61], v11 offset:49408
    v_mfma_f32_16x16x32_bf16 a[108:111], v[44:47], v[104:107], a[108:111]
    ds_read_b64_tr_b16 v[62:63], v11 offset:57600
    v_mfma_f32_16x16x32_bf16 a[160:163], v[32:35], v[112:115], a[160:163]
    v_mfma_f32_16x16x32_bf16 a[164:167], v[36:39], v[112:115], a[164:167]
    v_mfma_f32_16x16x32_bf16 a[168:171], v[40:43], v[112:115], a[168:171]
    v_mfma_f32_16x16x32_bf16 a[172:175], v[44:47], v[112:115], a[172:175]
    v_mfma_f32_16x16x32_bf16 a[224:227], v[32:35], v[120:123], a[224:227]
    v_mfma_f32_16x16x32_bf16 a[228:231], v[36:39], v[120:123], a[228:231]
    v_mfma_f32_16x16x32_bf16 a[232:235], v[40:43], v[120:123], a[232:235]
    v_mfma_f32_16x16x32_bf16 a[236:239], v[44:47], v[120:123], a[236:239]
    s_waitcnt lgkmcnt(0)
    v_mfma_f32_16x16x32_bf16 a[48:51], v[48:51], v[96:99], a[48:51]
    v_mfma_f32_16x16x32_bf16 a[52:55], v[52:55], v[96:99], a[52:55]
    v_mfma_f32_16x16x32_bf16 a[56:59], v[56:59], v[96:99], a[56:59]
    v_mfma_f32_16x16x32_bf16 a[60:63], v[60:63], v[96:99], a[60:63]
    v_mfma_f32_16x16x32_bf16 a[112:115], v[48:51], v[104:107], a[112:115]
    v_mfma_f32_16x16x32_bf16 a[116:119], v[52:55], v[104:107], a[116:119]
    v_mfma_f32_16x16x32_bf16 a[120:123], v[56:59], v[104:107], a[120:123]
    v_mfma_f32_16x16x32_bf16 a[124:127], v[60:63], v[104:107], a[124:127]
    v_mfma_f32_16x16x32_bf16 a[176:179], v[48:51], v[112:115], a[176:179]
    v_mfma_f32_16x16x32_bf16 a[180:183], v[52:55], v[112:115], a[180:183]
    v_mfma_f32_16x16x32_bf16 a[184:187], v[56:59], v[112:115], a[184:187]
    v_mfma_f32_16x16x32_bf16 a[188:191], v[60:63], v[112:115], a[188:191]
    v_mfma_f32_16x16x32_bf16 a[240:243], v[48:51], v[120:123], a[240:243]
    v_mfma_f32_16x16x32_bf16 a[244:247], v[52:55], v[120:123], a[244:247]
    v_mfma_f32_16x16x32_bf16 a[248:251], v[56:59], v[120:123], a[248:251]
    v_mfma_f32_16x16x32_bf16 a[252:255], v[60:63], v[120:123], a[252:255]
    s_barrier
    s_nop 7
    v_mov_b32 v28, v20
    v_mov_b32 v29, v21
    s_nop 1
    v_permlane16_swap_b32 v20, v28
    v_permlane16_swap_b32 v21, v29
    s_nop 1
    v_add_f32 v20, v20, v28
    v_add_f32 v21, v21, v29
    v_mov_b32 v28, v20
    v_mov_b32 v29, v21
    s_nop 1
    v_permlane32_swap_b32 v20, v28
    v_permlane32_swap_b32 v21, v29
    s_nop 1
    v_add_f32 v20, v20, v28
    v_add_f32 v21, v21, v29
    v_rcp_f32 v20, v20
    v_rcp_f32 v21, v21
    s_lshl_b32 s48, s41, 15
    s_lshl_b32 s49, s41, 13
    s_add_u32 s49, s49, 131072
    v_mbcnt_lo_u32_b32 v97, -1, 0
    v_mbcnt_hi_u32_b32 v97, -1, v97
    v_and_b32 v98, 15, v97
    v_lshrrev_b32 v99, 4, v97
    v_lshrrev_b32 v100, 1, v99
    v_and_b32 v99, 1, v99
    v_xor_b32 v100, v100, v98
    v_lshlrev_b32 v100, 4, v100
    v_lshl_add_u32 v100, v98, 9, v100
    v_lshl_add_u32 v100, v99, 3, v100
    v_add_u32 v64, s49, v100
    v_xor_b32 v65, 32, v64
    v_xor_b32 v66, 64, v64
    v_xor_b32 v67, 96, v64
    v_xor_b32 v68, 128, v64
    v_xor_b32 v69, 160, v64
    v_xor_b32 v70, 192, v64
    v_xor_b32 v71, 224, v64
    v_and_b32 v98, 31, v97
    v_lshrrev_b32 v99, 5, v97
    v_xor_b32 v100, v98, v99
    v_lshlrev_b32 v100, 4, v100
    v_lshl_add_u32 v100, v99, 9, v100
    v_add_u32 v72, s49, v100
    v_xor_b32 v73, 32, v72
    v_xor_b32 v74, 64, v72
    v_xor_b32 v75, 96, v72
    v_xor_b32 v76, 128, v72
    v_xor_b32 v77, 160, v72
    v_xor_b32 v78, 192, v72
    v_xor_b32 v79, 224, v72
    v_lshlrev_b32 v96, 4, v97
    v_add_u32 v96, s48, v96
    v_mov_b32 v98, v20
    v_mov_b32 v99, v20
    v_accvgpr_read_b32 v104, a0
    v_accvgpr_read_b32 v105, a1
    v_accvgpr_read_b32 v106, a2
    v_accvgpr_read_b32 v107, a3
    v_accvgpr_read_b32 v108, a4
    v_accvgpr_read_b32 v109, a5
    v_accvgpr_read_b32 v110, a6
    v_accvgpr_read_b32 v111, a7
    v_pk_mul_f32 v[104:105], v[104:105], v[98:99]
    v_pk_mul_f32 v[106:107], v[106:107], v[98:99]
    v_pk_mul_f32 v[108:109], v[108:109], v[98:99]
    v_pk_mul_f32 v[110:111], v[110:111], v[98:99]
    v_cvt_pk_bf16_f32 v104, v104, v105
    v_cvt_pk_bf16_f32 v105, v106, v107
    v_cvt_pk_bf16_f32 v108, v108, v109
    v_cvt_pk_bf16_f32 v109, v110, v111
    ds_write_b64 v64, v[104:105] offset:0
    ds_write_b64 v65, v[108:109] offset:0
    v_accvgpr_read_b32 v104, a8
    v_accvgpr_read_b32 v105, a9
    v_accvgpr_read_b32 v106, a10
    v_accvgpr_read_b32 v107, a11
    v_accvgpr_read_b32 v108, a12
    v_accvgpr_read_b32 v109, a13
    v_accvgpr_read_b32 v110, a14
    v_accvgpr_read_b32 v111, a15
    v_pk_mul_f32 v[104:105], v[104:105], v[98:99]
    v_pk_mul_f32 v[106:107], v[106:107], v[98:99]
    v_pk_mul_f32 v[108:109], v[108:109], v[98:99]
    v_pk_mul_f32 v[110:111], v[110:111], v[98:99]
    v_cvt_pk_bf16_f32 v104, v104, v105
    v_cvt_pk_bf16_f32 v105, v106, v107
    v_cvt_pk_bf16_f32 v108, v108, v109
    v_cvt_pk_bf16_f32 v109, v110, v111
    ds_write_b64 v66, v[104:105] offset:0
    ds_write_b64 v67, v[108:109] offset:0
    v_accvgpr_read_b32 v104, a16
    v_accvgpr_read_b32 v105, a17
    v_accvgpr_read_b32 v106, a18
    v_accvgpr_read_b32 v107, a19
    v_accvgpr_read_b32 v108, a20
    v_accvgpr_read_b32 v109, a21
    v_accvgpr_read_b32 v110, a22
    v_accvgpr_read_b32 v111, a23
    v_pk_mul_f32 v[104:105], v[104:105], v[98:99]
    v_pk_mul_f32 v[106:107], v[106:107], v[98:99]
    v_pk_mul_f32 v[108:109], v[108:109], v[98:99]
    v_pk_mul_f32 v[110:111], v[110:111], v[98:99]
    v_cvt_pk_bf16_f32 v104, v104, v105
    v_cvt_pk_bf16_f32 v105, v106, v107
    v_cvt_pk_bf16_f32 v108, v108, v109
    v_cvt_pk_bf16_f32 v109, v110, v111
    ds_write_b64 v68, v[104:105] offset:0
    ds_write_b64 v69, v[108:109] offset:0
    v_accvgpr_read_b32 v104, a24
    v_accvgpr_read_b32 v105, a25
    v_accvgpr_read_b32 v106, a26
    v_accvgpr_read_b32 v107, a27
    v_accvgpr_read_b32 v108, a28
    v_accvgpr_read_b32 v109, a29
    v_accvgpr_read_b32 v110, a30
    v_accvgpr_read_b32 v111, a31
    v_pk_mul_f32 v[104:105], v[104:105], v[98:99]
    v_pk_mul_f32 v[106:107], v[106:107], v[98:99]
    v_pk_mul_f32 v[108:109], v[108:109], v[98:99]
    v_pk_mul_f32 v[110:111], v[110:111], v[98:99]
    v_cvt_pk_bf16_f32 v104, v104, v105
    v_cvt_pk_bf16_f32 v105, v106, v107
    v_cvt_pk_bf16_f32 v108, v108, v109
    v_cvt_pk_bf16_f32 v109, v110, v111
    ds_write_b64 v70, v[104:105] offset:0
    ds_write_b64 v71, v[108:109] offset:0
    v_accvgpr_read_b32 v104, a32
    v_accvgpr_read_b32 v105, a33
    v_accvgpr_read_b32 v106, a34
    v_accvgpr_read_b32 v107, a35
    v_accvgpr_read_b32 v108, a36
    v_accvgpr_read_b32 v109, a37
    v_accvgpr_read_b32 v110, a38
    v_accvgpr_read_b32 v111, a39
    v_pk_mul_f32 v[104:105], v[104:105], v[98:99]
    v_pk_mul_f32 v[106:107], v[106:107], v[98:99]
    v_pk_mul_f32 v[108:109], v[108:109], v[98:99]
    v_pk_mul_f32 v[110:111], v[110:111], v[98:99]
    v_cvt_pk_bf16_f32 v104, v104, v105
    v_cvt_pk_bf16_f32 v105, v106, v107
    v_cvt_pk_bf16_f32 v108, v108, v109
    v_cvt_pk_bf16_f32 v109, v110, v111
    ds_write_b64 v64, v[104:105] offset:256
    ds_write_b64 v65, v[108:109] offset:256
    v_accvgpr_read_b32 v104, a40
    v_accvgpr_read_b32 v105, a41
    v_accvgpr_read_b32 v106, a42
    v_accvgpr_read_b32 v107, a43
    v_accvgpr_read_b32 v108, a44
    v_accvgpr_read_b32 v109, a45
    v_accvgpr_read_b32 v110, a46
    v_accvgpr_read_b32 v111, a47
    v_pk_mul_f32 v[104:105], v[104:105], v[98:99]
    v_pk_mul_f32 v[106:107], v[106:107], v[98:99]
    v_pk_mul_f32 v[108:109], v[108:109], v[98:99]
    v_pk_mul_f32 v[110:111], v[110:111], v[98:99]
    v_cvt_pk_bf16_f32 v104, v104, v105
    v_cvt_pk_bf16_f32 v105, v106, v107
    v_cvt_pk_bf16_f32 v108, v108, v109
    v_cvt_pk_bf16_f32 v109, v110, v111
    ds_write_b64 v66, v[104:105] offset:256
    ds_write_b64 v67, v[108:109] offset:256
    v_accvgpr_read_b32 v104, a48
    v_accvgpr_read_b32 v105, a49
    v_accvgpr_read_b32 v106, a50
    v_accvgpr_read_b32 v107, a51
    v_accvgpr_read_b32 v108, a52
    v_accvgpr_read_b32 v109, a53
    v_accvgpr_read_b32 v110, a54
    v_accvgpr_read_b32 v111, a55
    v_pk_mul_f32 v[104:105], v[104:105], v[98:99]
    v_pk_mul_f32 v[106:107], v[106:107], v[98:99]
    v_pk_mul_f32 v[108:109], v[108:109], v[98:99]
    v_pk_mul_f32 v[110:111], v[110:111], v[98:99]
    v_cvt_pk_bf16_f32 v104, v104, v105
    v_cvt_pk_bf16_f32 v105, v106, v107
    v_cvt_pk_bf16_f32 v108, v108, v109
    v_cvt_pk_bf16_f32 v109, v110, v111
    ds_write_b64 v68, v[104:105] offset:256
    ds_write_b64 v69, v[108:109] offset:256
    v_accvgpr_read_b32 v104, a56
    v_accvgpr_read_b32 v105, a57
    v_accvgpr_read_b32 v106, a58
    v_accvgpr_read_b32 v107, a59
    v_accvgpr_read_b32 v108, a60
    v_accvgpr_read_b32 v109, a61
    v_accvgpr_read_b32 v110, a62
    v_accvgpr_read_b32 v111, a63
    v_pk_mul_f32 v[104:105], v[104:105], v[98:99]
    v_pk_mul_f32 v[106:107], v[106:107], v[98:99]
    v_pk_mul_f32 v[108:109], v[108:109], v[98:99]
    v_pk_mul_f32 v[110:111], v[110:111], v[98:99]
    v_cvt_pk_bf16_f32 v104, v104, v105
    v_cvt_pk_bf16_f32 v105, v106, v107
    v_cvt_pk_bf16_f32 v108, v108, v109
    v_cvt_pk_bf16_f32 v109, v110, v111
    ds_write_b64 v70, v[104:105] offset:256
    ds_write_b64 v71, v[108:109] offset:256
    s_waitcnt lgkmcnt(0)
    ds_read_b128 v[128:131], v72 offset:0
    ds_read_b128 v[132:135], v73 offset:1024
    ds_read_b128 v[136:139], v74 offset:2048
    ds_read_b128 v[140:143], v75 offset:3072
    ds_read_b128 v[144:147], v76 offset:4096
    ds_read_b128 v[148:151], v77 offset:5120
    ds_read_b128 v[152:155], v78 offset:6144
    ds_read_b128 v[156:159], v79 offset:7168
    v_mov_b32 v98, v21
    v_mov_b32 v99, v21
    v_accvgpr_read_b32 v104, a64
    v_accvgpr_read_b32 v105, a65
    v_accvgpr_read_b32 v106, a66
    v_accvgpr_read_b32 v107, a67
    v_accvgpr_read_b32 v108, a68
    v_accvgpr_read_b32 v109, a69
    v_accvgpr_read_b32 v110, a70
    v_accvgpr_read_b32 v111, a71
    v_pk_mul_f32 v[104:105], v[104:105], v[98:99]
    v_pk_mul_f32 v[106:107], v[106:107], v[98:99]
    v_pk_mul_f32 v[108:109], v[108:109], v[98:99]
    v_pk_mul_f32 v[110:111], v[110:111], v[98:99]
    v_cvt_pk_bf16_f32 v104, v104, v105
    v_cvt_pk_bf16_f32 v105, v106, v107
    v_cvt_pk_bf16_f32 v108, v108, v109
    v_cvt_pk_bf16_f32 v109, v110, v111
    s_waitcnt lgkmcnt(0)
    ds_write_b64 v64, v[104:105] offset:0
    ds_write_b64 v65, v[108:109] offset:0
    v_accvgpr_read_b32 v104, a72
    v_accvgpr_read_b32 v105, a73
    v_accvgpr_read_b32 v106, a74
    v_accvgpr_read_b32 v107, a75
    v_accvgpr_read_b32 v108, a76
    v_accvgpr_read_b32 v109, a77
    v_accvgpr_read_b32 v110, a78
    v_accvgpr_read_b32 v111, a79
    v_pk_mul_f32 v[104:105], v[104:105], v[98:99]
    v_pk_mul_f32 v[106:107], v[106:107], v[98:99]
    v_pk_mul_f32 v[108:109], v[108:109], v[98:99]
    v_pk_mul_f32 v[110:111], v[110:111], v[98:99]
    v_cvt_pk_bf16_f32 v104, v104, v105
    v_cvt_pk_bf16_f32 v105, v106, v107
    v_cvt_pk_bf16_f32 v108, v108, v109
    v_cvt_pk_bf16_f32 v109, v110, v111
    ds_write_b64 v66, v[104:105] offset:0
    ds_write_b64 v67, v[108:109] offset:0
    buffer_store_dwordx4 v[128:131], v96, s[24:27], s50 offen offset:0 sc1
    v_accvgpr_read_b32 v104, a80
    v_accvgpr_read_b32 v105, a81
    v_accvgpr_read_b32 v106, a82
    v_accvgpr_read_b32 v107, a83
    v_accvgpr_read_b32 v108, a84
    v_accvgpr_read_b32 v109, a85
    v_accvgpr_read_b32 v110, a86
    v_accvgpr_read_b32 v111, a87
    v_pk_mul_f32 v[104:105], v[104:105], v[98:99]
    v_pk_mul_f32 v[106:107], v[106:107], v[98:99]
    v_pk_mul_f32 v[108:109], v[108:109], v[98:99]
    v_pk_mul_f32 v[110:111], v[110:111], v[98:99]
    v_cvt_pk_bf16_f32 v104, v104, v105
    v_cvt_pk_bf16_f32 v105, v106, v107
    v_cvt_pk_bf16_f32 v108, v108, v109
    v_cvt_pk_bf16_f32 v109, v110, v111
    ds_write_b64 v68, v[104:105] offset:0
    ds_write_b64 v69, v[108:109] offset:0
    buffer_store_dwordx4 v[132:135], v96, s[24:27], s50 offen offset:1024 sc1
    v_accvgpr_read_b32 v104, a88
    v_accvgpr_read_b32 v105, a89
    v_accvgpr_read_b32 v106, a90
    v_accvgpr_read_b32 v107, a91
    v_accvgpr_read_b32 v108, a92
    v_accvgpr_read_b32 v109, a93
    v_accvgpr_read_b32 v110, a94
    v_accvgpr_read_b32 v111, a95
    v_pk_mul_f32 v[104:105], v[104:105], v[98:99]
    v_pk_mul_f32 v[106:107], v[106:107], v[98:99]
    v_pk_mul_f32 v[108:109], v[108:109], v[98:99]
    v_pk_mul_f32 v[110:111], v[110:111], v[98:99]
    v_cvt_pk_bf16_f32 v104, v104, v105
    v_cvt_pk_bf16_f32 v105, v106, v107
    v_cvt_pk_bf16_f32 v108, v108, v109
    v_cvt_pk_bf16_f32 v109, v110, v111
    ds_write_b64 v70, v[104:105] offset:0
    ds_write_b64 v71, v[108:109] offset:0
    buffer_store_dwordx4 v[136:139], v96, s[24:27], s50 offen offset:2048 sc1
    v_accvgpr_read_b32 v104, a96
    v_accvgpr_read_b32 v105, a97
    v_accvgpr_read_b32 v106, a98
    v_accvgpr_read_b32 v107, a99
    v_accvgpr_read_b32 v108, a100
    v_accvgpr_read_b32 v109, a101
    v_accvgpr_read_b32 v110, a102
    v_accvgpr_read_b32 v111, a103
    v_pk_mul_f32 v[104:105], v[104:105], v[98:99]
    v_pk_mul_f32 v[106:107], v[106:107], v[98:99]
    v_pk_mul_f32 v[108:109], v[108:109], v[98:99]
    v_pk_mul_f32 v[110:111], v[110:111], v[98:99]
    v_cvt_pk_bf16_f32 v104, v104, v105
    v_cvt_pk_bf16_f32 v105, v106, v107
    v_cvt_pk_bf16_f32 v108, v108, v109
    v_cvt_pk_bf16_f32 v109, v110, v111
    ds_write_b64 v64, v[104:105] offset:256
    ds_write_b64 v65, v[108:109] offset:256
    buffer_store_dwordx4 v[140:143], v96, s[24:27], s50 offen offset:3072 sc1
    v_accvgpr_read_b32 v104, a104
    v_accvgpr_read_b32 v105, a105
    v_accvgpr_read_b32 v106, a106
    v_accvgpr_read_b32 v107, a107
    v_accvgpr_read_b32 v108, a108
    v_accvgpr_read_b32 v109, a109
    v_accvgpr_read_b32 v110, a110
    v_accvgpr_read_b32 v111, a111
    v_pk_mul_f32 v[104:105], v[104:105], v[98:99]
    v_pk_mul_f32 v[106:107], v[106:107], v[98:99]
    v_pk_mul_f32 v[108:109], v[108:109], v[98:99]
    v_pk_mul_f32 v[110:111], v[110:111], v[98:99]
    v_cvt_pk_bf16_f32 v104, v104, v105
    v_cvt_pk_bf16_f32 v105, v106, v107
    v_cvt_pk_bf16_f32 v108, v108, v109
    v_cvt_pk_bf16_f32 v109, v110, v111
    ds_write_b64 v66, v[104:105] offset:256
    ds_write_b64 v67, v[108:109] offset:256
    buffer_store_dwordx4 v[144:147], v96, s[24:27], s51 offen offset:0 sc1
    v_accvgpr_read_b32 v104, a112
    v_accvgpr_read_b32 v105, a113
    v_accvgpr_read_b32 v106, a114
    v_accvgpr_read_b32 v107, a115
    v_accvgpr_read_b32 v108, a116
    v_accvgpr_read_b32 v109, a117
    v_accvgpr_read_b32 v110, a118
    v_accvgpr_read_b32 v111, a119
    v_pk_mul_f32 v[104:105], v[104:105], v[98:99]
    v_pk_mul_f32 v[106:107], v[106:107], v[98:99]
    v_pk_mul_f32 v[108:109], v[108:109], v[98:99]
    v_pk_mul_f32 v[110:111], v[110:111], v[98:99]
    v_cvt_pk_bf16_f32 v104, v104, v105
    v_cvt_pk_bf16_f32 v105, v106, v107
    v_cvt_pk_bf16_f32 v108, v108, v109
    v_cvt_pk_bf16_f32 v109, v110, v111
    ds_write_b64 v68, v[104:105] offset:256
    ds_write_b64 v69, v[108:109] offset:256
    buffer_store_dwordx4 v[148:151], v96, s[24:27], s51 offen offset:1024 sc1
    v_accvgpr_read_b32 v104, a120
    v_accvgpr_read_b32 v105, a121
    v_accvgpr_read_b32 v106, a122
    v_accvgpr_read_b32 v107, a123
    v_accvgpr_read_b32 v108, a124
    v_accvgpr_read_b32 v109, a125
    v_accvgpr_read_b32 v110, a126
    v_accvgpr_read_b32 v111, a127
    v_pk_mul_f32 v[104:105], v[104:105], v[98:99]
    v_pk_mul_f32 v[106:107], v[106:107], v[98:99]
    v_pk_mul_f32 v[108:109], v[108:109], v[98:99]
    v_pk_mul_f32 v[110:111], v[110:111], v[98:99]
    v_cvt_pk_bf16_f32 v104, v104, v105
    v_cvt_pk_bf16_f32 v105, v106, v107
    v_cvt_pk_bf16_f32 v108, v108, v109
    v_cvt_pk_bf16_f32 v109, v110, v111
    ds_write_b64 v70, v[104:105] offset:256
    ds_write_b64 v71, v[108:109] offset:256
    buffer_store_dwordx4 v[152:155], v96, s[24:27], s51 offen offset:2048 sc1
    buffer_store_dwordx4 v[156:159], v96, s[24:27], s51 offen offset:3072 sc1
    s_waitcnt lgkmcnt(0)
    ds_read_b128 v[160:163], v72 offset:0
    ds_read_b128 v[164:167], v73 offset:1024
    ds_read_b128 v[168:171], v74 offset:2048
    ds_read_b128 v[172:175], v75 offset:3072
    ds_read_b128 v[176:179], v76 offset:4096
    ds_read_b128 v[180:183], v77 offset:5120
    ds_read_b128 v[184:187], v78 offset:6144
    ds_read_b128 v[188:191], v79 offset:7168
    s_waitcnt lgkmcnt(0)
    buffer_store_dwordx4 v[160:163], v96, s[24:27], s52 offen offset:0 sc1
    buffer_store_dwordx4 v[164:167], v96, s[24:27], s52 offen offset:1024 sc1
    buffer_store_dwordx4 v[168:171], v96, s[24:27], s52 offen offset:2048 sc1
    buffer_store_dwordx4 v[172:175], v96, s[24:27], s52 offen offset:3072 sc1
    buffer_store_dwordx4 v[176:179], v96, s[24:27], s53 offen offset:0 sc1
    buffer_store_dwordx4 v[180:183], v96, s[24:27], s53 offen offset:1024 sc1
    buffer_store_dwordx4 v[184:187], v96, s[24:27], s53 offen offset:2048 sc1
    buffer_store_dwordx4 v[188:191], v96, s[24:27], s53 offen offset:3072 sc1
    v_mov_b32 v28, v22
    v_mov_b32 v29, v23
    s_nop 1
    v_permlane16_swap_b32 v22, v28
    v_permlane16_swap_b32 v23, v29
    s_nop 1
    v_add_f32 v22, v22, v28
    v_add_f32 v23, v23, v29
    v_mov_b32 v28, v22
    v_mov_b32 v29, v23
    s_nop 1
    v_permlane32_swap_b32 v22, v28
    v_permlane32_swap_b32 v23, v29
    s_nop 1
    v_add_f32 v22, v22, v28
    v_add_f32 v23, v23, v29
    v_rcp_f32 v22, v22
    v_rcp_f32 v23, v23
    s_lshl_b32 s48, s41, 15
    s_lshl_b32 s49, s41, 13
    s_add_u32 s49, s49, 131072
    v_mbcnt_lo_u32_b32 v113, -1, 0
    v_mbcnt_hi_u32_b32 v113, -1, v113
    v_and_b32 v114, 15, v113
    v_lshrrev_b32 v115, 4, v113
    v_lshrrev_b32 v116, 1, v115
    v_and_b32 v115, 1, v115
    v_xor_b32 v116, v116, v114
    v_lshlrev_b32 v116, 4, v116
    v_lshl_add_u32 v116, v114, 9, v116
    v_lshl_add_u32 v116, v115, 3, v116
    v_add_u32 v80, s49, v116
    v_xor_b32 v81, 32, v80
    v_xor_b32 v82, 64, v80
    v_xor_b32 v83, 96, v80
    v_xor_b32 v84, 128, v80
    v_xor_b32 v85, 160, v80
    v_xor_b32 v86, 192, v80
    v_xor_b32 v87, 224, v80
    v_and_b32 v114, 31, v113
    v_lshrrev_b32 v115, 5, v113
    v_xor_b32 v116, v114, v115
    v_lshlrev_b32 v116, 4, v116
    v_lshl_add_u32 v116, v115, 9, v116
    v_add_u32 v88, s49, v116
    v_xor_b32 v89, 32, v88
    v_xor_b32 v90, 64, v88
    v_xor_b32 v91, 96, v88
    v_xor_b32 v92, 128, v88
    v_xor_b32 v93, 160, v88
    v_xor_b32 v94, 192, v88
    v_xor_b32 v95, 224, v88
    v_lshlrev_b32 v112, 4, v113
    v_add_u32 v112, s48, v112
    v_mov_b32 v114, v22
    v_mov_b32 v115, v22
    v_accvgpr_read_b32 v120, a128
    v_accvgpr_read_b32 v121, a129
    v_accvgpr_read_b32 v122, a130
    v_accvgpr_read_b32 v123, a131
    v_accvgpr_read_b32 v124, a132
    v_accvgpr_read_b32 v125, a133
    v_accvgpr_read_b32 v126, a134
    v_accvgpr_read_b32 v127, a135
    v_pk_mul_f32 v[120:121], v[120:121], v[114:115]
    v_pk_mul_f32 v[122:123], v[122:123], v[114:115]
    v_pk_mul_f32 v[124:125], v[124:125], v[114:115]
    v_pk_mul_f32 v[126:127], v[126:127], v[114:115]
    v_cvt_pk_bf16_f32 v120, v120, v121
    v_cvt_pk_bf16_f32 v121, v122, v123
    v_cvt_pk_bf16_f32 v124, v124, v125
    v_cvt_pk_bf16_f32 v125, v126, v127
    ds_write_b64 v80, v[120:121] offset:0
    ds_write_b64 v81, v[124:125] offset:0
    v_accvgpr_read_b32 v120, a136
    v_accvgpr_read_b32 v121, a137
    v_accvgpr_read_b32 v122, a138
    v_accvgpr_read_b32 v123, a139
    v_accvgpr_read_b32 v124, a140
    v_accvgpr_read_b32 v125, a141
    v_accvgpr_read_b32 v126, a142
    v_accvgpr_read_b32 v127, a143
    v_pk_mul_f32 v[120:121], v[120:121], v[114:115]
    v_pk_mul_f32 v[122:123], v[122:123], v[114:115]
    v_pk_mul_f32 v[124:125], v[124:125], v[114:115]
    v_pk_mul_f32 v[126:127], v[126:127], v[114:115]
    v_cvt_pk_bf16_f32 v120, v120, v121
    v_cvt_pk_bf16_f32 v121, v122, v123
    v_cvt_pk_bf16_f32 v124, v124, v125
    v_cvt_pk_bf16_f32 v125, v126, v127
    ds_write_b64 v82, v[120:121] offset:0
    ds_write_b64 v83, v[124:125] offset:0
    v_accvgpr_read_b32 v120, a144
    v_accvgpr_read_b32 v121, a145
    v_accvgpr_read_b32 v122, a146
    v_accvgpr_read_b32 v123, a147
    v_accvgpr_read_b32 v124, a148
    v_accvgpr_read_b32 v125, a149
    v_accvgpr_read_b32 v126, a150
    v_accvgpr_read_b32 v127, a151
    v_pk_mul_f32 v[120:121], v[120:121], v[114:115]
    v_pk_mul_f32 v[122:123], v[122:123], v[114:115]
    v_pk_mul_f32 v[124:125], v[124:125], v[114:115]
    v_pk_mul_f32 v[126:127], v[126:127], v[114:115]
    v_cvt_pk_bf16_f32 v120, v120, v121
    v_cvt_pk_bf16_f32 v121, v122, v123
    v_cvt_pk_bf16_f32 v124, v124, v125
    v_cvt_pk_bf16_f32 v125, v126, v127
    ds_write_b64 v84, v[120:121] offset:0
    ds_write_b64 v85, v[124:125] offset:0
    v_accvgpr_read_b32 v120, a152
    v_accvgpr_read_b32 v121, a153
    v_accvgpr_read_b32 v122, a154
    v_accvgpr_read_b32 v123, a155
    v_accvgpr_read_b32 v124, a156
    v_accvgpr_read_b32 v125, a157
    v_accvgpr_read_b32 v126, a158
    v_accvgpr_read_b32 v127, a159
    v_pk_mul_f32 v[120:121], v[120:121], v[114:115]
    v_pk_mul_f32 v[122:123], v[122:123], v[114:115]
    v_pk_mul_f32 v[124:125], v[124:125], v[114:115]
    v_pk_mul_f32 v[126:127], v[126:127], v[114:115]
    v_cvt_pk_bf16_f32 v120, v120, v121
    v_cvt_pk_bf16_f32 v121, v122, v123
    v_cvt_pk_bf16_f32 v124, v124, v125
    v_cvt_pk_bf16_f32 v125, v126, v127
    ds_write_b64 v86, v[120:121] offset:0
    ds_write_b64 v87, v[124:125] offset:0
    v_accvgpr_read_b32 v120, a160
    v_accvgpr_read_b32 v121, a161
    v_accvgpr_read_b32 v122, a162
    v_accvgpr_read_b32 v123, a163
    v_accvgpr_read_b32 v124, a164
    v_accvgpr_read_b32 v125, a165
    v_accvgpr_read_b32 v126, a166
    v_accvgpr_read_b32 v127, a167
    v_pk_mul_f32 v[120:121], v[120:121], v[114:115]
    v_pk_mul_f32 v[122:123], v[122:123], v[114:115]
    v_pk_mul_f32 v[124:125], v[124:125], v[114:115]
    v_pk_mul_f32 v[126:127], v[126:127], v[114:115]
    v_cvt_pk_bf16_f32 v120, v120, v121
    v_cvt_pk_bf16_f32 v121, v122, v123
    v_cvt_pk_bf16_f32 v124, v124, v125
    v_cvt_pk_bf16_f32 v125, v126, v127
    ds_write_b64 v80, v[120:121] offset:256
    ds_write_b64 v81, v[124:125] offset:256
    v_accvgpr_read_b32 v120, a168
    v_accvgpr_read_b32 v121, a169
    v_accvgpr_read_b32 v122, a170
    v_accvgpr_read_b32 v123, a171
    v_accvgpr_read_b32 v124, a172
    v_accvgpr_read_b32 v125, a173
    v_accvgpr_read_b32 v126, a174
    v_accvgpr_read_b32 v127, a175
    v_pk_mul_f32 v[120:121], v[120:121], v[114:115]
    v_pk_mul_f32 v[122:123], v[122:123], v[114:115]
    v_pk_mul_f32 v[124:125], v[124:125], v[114:115]
    v_pk_mul_f32 v[126:127], v[126:127], v[114:115]
    v_cvt_pk_bf16_f32 v120, v120, v121
    v_cvt_pk_bf16_f32 v121, v122, v123
    v_cvt_pk_bf16_f32 v124, v124, v125
    v_cvt_pk_bf16_f32 v125, v126, v127
    ds_write_b64 v82, v[120:121] offset:256
    ds_write_b64 v83, v[124:125] offset:256
    v_accvgpr_read_b32 v120, a176
    v_accvgpr_read_b32 v121, a177
    v_accvgpr_read_b32 v122, a178
    v_accvgpr_read_b32 v123, a179
    v_accvgpr_read_b32 v124, a180
    v_accvgpr_read_b32 v125, a181
    v_accvgpr_read_b32 v126, a182
    v_accvgpr_read_b32 v127, a183
    v_pk_mul_f32 v[120:121], v[120:121], v[114:115]
    v_pk_mul_f32 v[122:123], v[122:123], v[114:115]
    v_pk_mul_f32 v[124:125], v[124:125], v[114:115]
    v_pk_mul_f32 v[126:127], v[126:127], v[114:115]
    v_cvt_pk_bf16_f32 v120, v120, v121
    v_cvt_pk_bf16_f32 v121, v122, v123
    v_cvt_pk_bf16_f32 v124, v124, v125
    v_cvt_pk_bf16_f32 v125, v126, v127
    ds_write_b64 v84, v[120:121] offset:256
    ds_write_b64 v85, v[124:125] offset:256
    v_accvgpr_read_b32 v120, a184
    v_accvgpr_read_b32 v121, a185
    v_accvgpr_read_b32 v122, a186
    v_accvgpr_read_b32 v123, a187
    v_accvgpr_read_b32 v124, a188
    v_accvgpr_read_b32 v125, a189
    v_accvgpr_read_b32 v126, a190
    v_accvgpr_read_b32 v127, a191
    v_pk_mul_f32 v[120:121], v[120:121], v[114:115]
    v_pk_mul_f32 v[122:123], v[122:123], v[114:115]
    v_pk_mul_f32 v[124:125], v[124:125], v[114:115]
    v_pk_mul_f32 v[126:127], v[126:127], v[114:115]
    v_cvt_pk_bf16_f32 v120, v120, v121
    v_cvt_pk_bf16_f32 v121, v122, v123
    v_cvt_pk_bf16_f32 v124, v124, v125
    v_cvt_pk_bf16_f32 v125, v126, v127
    ds_write_b64 v86, v[120:121] offset:256
    ds_write_b64 v87, v[124:125] offset:256
    s_waitcnt lgkmcnt(0)
    ds_read_b128 v[192:195], v88 offset:0
    ds_read_b128 v[196:199], v89 offset:1024
    ds_read_b128 v[200:203], v90 offset:2048
    ds_read_b128 v[204:207], v91 offset:3072
    ds_read_b128 v[208:211], v92 offset:4096
    ds_read_b128 v[212:215], v93 offset:5120
    ds_read_b128 v[216:219], v94 offset:6144
    ds_read_b128 v[220:223], v95 offset:7168
    v_mov_b32 v114, v23
    v_mov_b32 v115, v23
    v_accvgpr_read_b32 v120, a192
    v_accvgpr_read_b32 v121, a193
    v_accvgpr_read_b32 v122, a194
    v_accvgpr_read_b32 v123, a195
    v_accvgpr_read_b32 v124, a196
    v_accvgpr_read_b32 v125, a197
    v_accvgpr_read_b32 v126, a198
    v_accvgpr_read_b32 v127, a199
    v_pk_mul_f32 v[120:121], v[120:121], v[114:115]
    v_pk_mul_f32 v[122:123], v[122:123], v[114:115]
    v_pk_mul_f32 v[124:125], v[124:125], v[114:115]
    v_pk_mul_f32 v[126:127], v[126:127], v[114:115]
    v_cvt_pk_bf16_f32 v120, v120, v121
    v_cvt_pk_bf16_f32 v121, v122, v123
    v_cvt_pk_bf16_f32 v124, v124, v125
    v_cvt_pk_bf16_f32 v125, v126, v127
    s_waitcnt lgkmcnt(0)
    ds_write_b64 v80, v[120:121] offset:0
    ds_write_b64 v81, v[124:125] offset:0
    v_accvgpr_read_b32 v120, a200
    v_accvgpr_read_b32 v121, a201
    v_accvgpr_read_b32 v122, a202
    v_accvgpr_read_b32 v123, a203
    v_accvgpr_read_b32 v124, a204
    v_accvgpr_read_b32 v125, a205
    v_accvgpr_read_b32 v126, a206
    v_accvgpr_read_b32 v127, a207
    v_pk_mul_f32 v[120:121], v[120:121], v[114:115]
    v_pk_mul_f32 v[122:123], v[122:123], v[114:115]
    v_pk_mul_f32 v[124:125], v[124:125], v[114:115]
    v_pk_mul_f32 v[126:127], v[126:127], v[114:115]
    v_cvt_pk_bf16_f32 v120, v120, v121
    v_cvt_pk_bf16_f32 v121, v122, v123
    v_cvt_pk_bf16_f32 v124, v124, v125
    v_cvt_pk_bf16_f32 v125, v126, v127
    ds_write_b64 v82, v[120:121] offset:0
    ds_write_b64 v83, v[124:125] offset:0
    buffer_store_dwordx4 v[192:195], v112, s[24:27], s54 offen offset:0 sc1
    v_accvgpr_read_b32 v120, a208
    v_accvgpr_read_b32 v121, a209
    v_accvgpr_read_b32 v122, a210
    v_accvgpr_read_b32 v123, a211
    v_accvgpr_read_b32 v124, a212
    v_accvgpr_read_b32 v125, a213
    v_accvgpr_read_b32 v126, a214
    v_accvgpr_read_b32 v127, a215
    v_pk_mul_f32 v[120:121], v[120:121], v[114:115]
    v_pk_mul_f32 v[122:123], v[122:123], v[114:115]
    v_pk_mul_f32 v[124:125], v[124:125], v[114:115]
    v_pk_mul_f32 v[126:127], v[126:127], v[114:115]
    v_cvt_pk_bf16_f32 v120, v120, v121
    v_cvt_pk_bf16_f32 v121, v122, v123
    v_cvt_pk_bf16_f32 v124, v124, v125
    v_cvt_pk_bf16_f32 v125, v126, v127
    ds_write_b64 v84, v[120:121] offset:0
    ds_write_b64 v85, v[124:125] offset:0
    buffer_store_dwordx4 v[196:199], v112, s[24:27], s54 offen offset:1024 sc1
    v_accvgpr_read_b32 v120, a216
    v_accvgpr_read_b32 v121, a217
    v_accvgpr_read_b32 v122, a218
    v_accvgpr_read_b32 v123, a219
    v_accvgpr_read_b32 v124, a220
    v_accvgpr_read_b32 v125, a221
    v_accvgpr_read_b32 v126, a222
    v_accvgpr_read_b32 v127, a223
    v_pk_mul_f32 v[120:121], v[120:121], v[114:115]
    v_pk_mul_f32 v[122:123], v[122:123], v[114:115]
    v_pk_mul_f32 v[124:125], v[124:125], v[114:115]
    v_pk_mul_f32 v[126:127], v[126:127], v[114:115]
    v_cvt_pk_bf16_f32 v120, v120, v121
    v_cvt_pk_bf16_f32 v121, v122, v123
    v_cvt_pk_bf16_f32 v124, v124, v125
    v_cvt_pk_bf16_f32 v125, v126, v127
    ds_write_b64 v86, v[120:121] offset:0
    ds_write_b64 v87, v[124:125] offset:0
    buffer_store_dwordx4 v[200:203], v112, s[24:27], s54 offen offset:2048 sc1
    v_accvgpr_read_b32 v120, a224
    v_accvgpr_read_b32 v121, a225
    v_accvgpr_read_b32 v122, a226
    v_accvgpr_read_b32 v123, a227
    v_accvgpr_read_b32 v124, a228
    v_accvgpr_read_b32 v125, a229
    v_accvgpr_read_b32 v126, a230
    v_accvgpr_read_b32 v127, a231
    v_pk_mul_f32 v[120:121], v[120:121], v[114:115]
    v_pk_mul_f32 v[122:123], v[122:123], v[114:115]
    v_pk_mul_f32 v[124:125], v[124:125], v[114:115]
    v_pk_mul_f32 v[126:127], v[126:127], v[114:115]
    v_cvt_pk_bf16_f32 v120, v120, v121
    v_cvt_pk_bf16_f32 v121, v122, v123
    v_cvt_pk_bf16_f32 v124, v124, v125
    v_cvt_pk_bf16_f32 v125, v126, v127
    ds_write_b64 v80, v[120:121] offset:256
    ds_write_b64 v81, v[124:125] offset:256
    buffer_store_dwordx4 v[204:207], v112, s[24:27], s54 offen offset:3072 sc1
    v_accvgpr_read_b32 v120, a232
    v_accvgpr_read_b32 v121, a233
    v_accvgpr_read_b32 v122, a234
    v_accvgpr_read_b32 v123, a235
    v_accvgpr_read_b32 v124, a236
    v_accvgpr_read_b32 v125, a237
    v_accvgpr_read_b32 v126, a238
    v_accvgpr_read_b32 v127, a239
    v_pk_mul_f32 v[120:121], v[120:121], v[114:115]
    v_pk_mul_f32 v[122:123], v[122:123], v[114:115]
    v_pk_mul_f32 v[124:125], v[124:125], v[114:115]
    v_pk_mul_f32 v[126:127], v[126:127], v[114:115]
    v_cvt_pk_bf16_f32 v120, v120, v121
    v_cvt_pk_bf16_f32 v121, v122, v123
    v_cvt_pk_bf16_f32 v124, v124, v125
    v_cvt_pk_bf16_f32 v125, v126, v127
    ds_write_b64 v82, v[120:121] offset:256
    ds_write_b64 v83, v[124:125] offset:256
    buffer_store_dwordx4 v[208:211], v112, s[24:27], s55 offen offset:0 sc1
    v_accvgpr_read_b32 v120, a240
    v_accvgpr_read_b32 v121, a241
    v_accvgpr_read_b32 v122, a242
    v_accvgpr_read_b32 v123, a243
    v_accvgpr_read_b32 v124, a244
    v_accvgpr_read_b32 v125, a245
    v_accvgpr_read_b32 v126, a246
    v_accvgpr_read_b32 v127, a247
    v_pk_mul_f32 v[120:121], v[120:121], v[114:115]
    v_pk_mul_f32 v[122:123], v[122:123], v[114:115]
    v_pk_mul_f32 v[124:125], v[124:125], v[114:115]
    v_pk_mul_f32 v[126:127], v[126:127], v[114:115]
    v_cvt_pk_bf16_f32 v120, v120, v121
    v_cvt_pk_bf16_f32 v121, v122, v123
    v_cvt_pk_bf16_f32 v124, v124, v125
    v_cvt_pk_bf16_f32 v125, v126, v127
    ds_write_b64 v84, v[120:121] offset:256
    ds_write_b64 v85, v[124:125] offset:256
    buffer_store_dwordx4 v[212:215], v112, s[24:27], s55 offen offset:1024 sc1
    v_accvgpr_read_b32 v120, a248
    v_accvgpr_read_b32 v121, a249
    v_accvgpr_read_b32 v122, a250
    v_accvgpr_read_b32 v123, a251
    v_accvgpr_read_b32 v124, a252
    v_accvgpr_read_b32 v125, a253
    v_accvgpr_read_b32 v126, a254
    v_accvgpr_read_b32 v127, a255
    v_pk_mul_f32 v[120:121], v[120:121], v[114:115]
    v_pk_mul_f32 v[122:123], v[122:123], v[114:115]
    v_pk_mul_f32 v[124:125], v[124:125], v[114:115]
    v_pk_mul_f32 v[126:127], v[126:127], v[114:115]
    v_cvt_pk_bf16_f32 v120, v120, v121
    v_cvt_pk_bf16_f32 v121, v122, v123
    v_cvt_pk_bf16_f32 v124, v124, v125
    v_cvt_pk_bf16_f32 v125, v126, v127
    ds_write_b64 v86, v[120:121] offset:256
    ds_write_b64 v87, v[124:125] offset:256
    buffer_store_dwordx4 v[216:219], v112, s[24:27], s55 offen offset:2048 sc1
    buffer_store_dwordx4 v[220:223], v112, s[24:27], s55 offen offset:3072 sc1
    s_waitcnt lgkmcnt(0)
    ds_read_b128 v[224:227], v88 offset:0
    ds_read_b128 v[228:231], v89 offset:1024
    ds_read_b128 v[232:235], v90 offset:2048
    ds_read_b128 v[236:239], v91 offset:3072
    ds_read_b128 v[240:243], v92 offset:4096
    ds_read_b128 v[244:247], v93 offset:5120
    ds_read_b128 v[248:251], v94 offset:6144
    ds_read_b128 v[252:255], v95 offset:7168
    s_waitcnt lgkmcnt(0)
    buffer_store_dwordx4 v[224:227], v112, s[24:27], s56 offen offset:0 sc1
    buffer_store_dwordx4 v[228:231], v112, s[24:27], s56 offen offset:1024 sc1
    buffer_store_dwordx4 v[232:235], v112, s[24:27], s56 offen offset:2048 sc1
    buffer_store_dwordx4 v[236:239], v112, s[24:27], s56 offen offset:3072 sc1
    buffer_store_dwordx4 v[240:243], v112, s[24:27], s57 offen offset:0 sc1
    buffer_store_dwordx4 v[244:247], v112, s[24:27], s57 offen offset:1024 sc1
    buffer_store_dwordx4 v[248:251], v112, s[24:27], s57 offen offset:2048 sc1
    buffer_store_dwordx4 v[252:255], v112, s[24:27], s57 offen offset:3072 sc1
L_end:
    s_endpgm
L_rare1:
    v_mov_b32 v28, v24
    v_mov_b32 v29, v25
    v_mov_b32 v30, v26
    v_mov_b32 v31, v27
    s_nop 1
    v_permlane16_swap_b32 v24, v28
    v_permlane16_swap_b32 v25, v29
    v_permlane16_swap_b32 v26, v30
    v_permlane16_swap_b32 v27, v31
    s_nop 1
    v_max_f32 v24, v24, v28
    v_max_f32 v25, v25, v29
    v_max_f32 v26, v26, v30
    v_max_f32 v27, v27, v31
    v_mov_b32 v28, v24
    v_mov_b32 v29, v25
    v_mov_b32 v30, v26
    v_mov_b32 v31, v27
    s_nop 1
    v_permlane32_swap_b32 v24, v28
    v_permlane32_swap_b32 v25, v29
    v_permlane32_swap_b32 v26, v30
    v_permlane32_swap_b32 v27, v31
    s_nop 1
    v_max_f32 v24, v24, v28
    v_max_f32 v25, v25, v29
    v_max_f32 v26, v26, v30
    v_max_f32 v27, v27, v31
    v_mul_f32 v28, s28, v24
    v_max_f32 v28, v28, -v16
    v_sub_f32 v24, -v16, v28
    v_exp_f32 v24, v24
    v_sub_f32 v16, 0, v28
    v_mul_f32 v20, v20, v24
    v_mul_f32 v29, s28, v25
    v_max_f32 v29, v29, -v17
    v_sub_f32 v25, -v17, v29
    v_exp_f32 v25, v25
    v_sub_f32 v17, 0, v29
    v_mul_f32 v21, v21, v25
    v_mul_f32 v30, s28, v26
    v_max_f32 v30, v30, -v18
    v_sub_f32 v26, -v18, v30
    v_exp_f32 v26, v26
    v_sub_f32 v18, 0, v30
    v_mul_f32 v22, v22, v26
    v_mul_f32 v31, s28, v27
    v_max_f32 v31, v31, -v19
    v_sub_f32 v27, -v19, v31
    v_exp_f32 v27, v27
    v_sub_f32 v19, 0, v31
    v_mul_f32 v23, v23, v27
    s_mov_b32 s33, 1
    s_setpc_b64 s[34:35]
L_rare2:
    s_nop 9
    v_accvgpr_read_b32 v28, a0
    v_accvgpr_read_b32 v29, a1
    v_accvgpr_read_b32 v30, a2
    v_accvgpr_read_b32 v31, a3
    v_mul_f32 v28, v28, v24
    v_mul_f32 v29, v29, v24
    v_mul_f32 v30, v30, v24
    v_mul_f32 v31, v31, v24
    v_accvgpr_write_b32 a0, v28
    v_accvgpr_write_b32 a1, v29
    v_accvgpr_write_b32 a2, v30
    v_accvgpr_write_b32 a3, v31
    v_accvgpr_read_b32 v28, a4
    v_accvgpr_read_b32 v29, a5
    v_accvgpr_read_b32 v30, a6
    v_accvgpr_read_b32 v31, a7
    v_mul_f32 v28, v28, v24
    v_mul_f32 v29, v29, v24
    v_mul_f32 v30, v30, v24
    v_mul_f32 v31, v31, v24
    v_accvgpr_write_b32 a4, v28
    v_accvgpr_write_b32 a5, v29
    v_accvgpr_write_b32 a6, v30
    v_accvgpr_write_b32 a7, v31
    v_accvgpr_read_b32 v28, a8
    v_accvgpr_read_b32 v29, a9
    v_accvgpr_read_b32 v30, a10
    v_accvgpr_read_b32 v31, a11
    v_mul_f32 v28, v28, v24
    v_mul_f32 v29, v29, v24
    v_mul_f32 v30, v30, v24
    v_mul_f32 v31, v31, v24
    v_accvgpr_write_b32 a8, v28
    v_accvgpr_write_b32 a9, v29
    v_accvgpr_write_b32 a10, v30
    v_accvgpr_write_b32 a11, v31
    v_accvgpr_read_b32 v28, a12
    v_accvgpr_read_b32 v29, a13
    v_accvgpr_read_b32 v30, a14
    v_accvgpr_read_b32 v31, a15
    v_mul_f32 v28, v28, v24
    v_mul_f32 v29, v29, v24
    v_mul_f32 v30, v30, v24
    v_mul_f32 v31, v31, v24
    v_accvgpr_write_b32 a12, v28
    v_accvgpr_write_b32 a13, v29
    v_accvgpr_write_b32 a14, v30
    v_accvgpr_write_b32 a15, v31
    v_accvgpr_read_b32 v28, a16
    v_accvgpr_read_b32 v29, a17
    v_accvgpr_read_b32 v30, a18
    v_accvgpr_read_b32 v31, a19
    v_mul_f32 v28, v28, v24
    v_mul_f32 v29, v29, v24
    v_mul_f32 v30, v30, v24
    v_mul_f32 v31, v31, v24
    v_accvgpr_write_b32 a16, v28
    v_accvgpr_write_b32 a17, v29
    v_accvgpr_write_b32 a18, v30
    v_accvgpr_write_b32 a19, v31
    v_accvgpr_read_b32 v28, a20
    v_accvgpr_read_b32 v29, a21
    v_accvgpr_read_b32 v30, a22
    v_accvgpr_read_b32 v31, a23
    v_mul_f32 v28, v28, v24
    v_mul_f32 v29, v29, v24
    v_mul_f32 v30, v30, v24
    v_mul_f32 v31, v31, v24
    v_accvgpr_write_b32 a20, v28
    v_accvgpr_write_b32 a21, v29
    v_accvgpr_write_b32 a22, v30
    v_accvgpr_write_b32 a23, v31
    v_accvgpr_read_b32 v28, a24
    v_accvgpr_read_b32 v29, a25
    v_accvgpr_read_b32 v30, a26
    v_accvgpr_read_b32 v31, a27
    v_mul_f32 v28, v28, v24
    v_mul_f32 v29, v29, v24
    v_mul_f32 v30, v30, v24
    v_mul_f32 v31, v31, v24
    v_accvgpr_write_b32 a24, v28
    v_accvgpr_write_b32 a25, v29
    v_accvgpr_write_b32 a26, v30
    v_accvgpr_write_b32 a27, v31
    v_accvgpr_read_b32 v28, a28
    v_accvgpr_read_b32 v29, a29
    v_accvgpr_read_b32 v30, a30
    v_accvgpr_read_b32 v31, a31
    v_mul_f32 v28, v28, v24
    v_mul_f32 v29, v29, v24
    v_mul_f32 v30, v30, v24
    v_mul_f32 v31, v31, v24
    v_accvgpr_write_b32 a28, v28
    v_accvgpr_write_b32 a29, v29
    v_accvgpr_write_b32 a30, v30
    v_accvgpr_write_b32 a31, v31
    v_accvgpr_read_b32 v28, a32
    v_accvgpr_read_b32 v29, a33
    v_accvgpr_read_b32 v30, a34
    v_accvgpr_read_b32 v31, a35
    v_mul_f32 v28, v28, v24
    v_mul_f32 v29, v29, v24
    v_mul_f32 v30, v30, v24
    v_mul_f32 v31, v31, v24
    v_accvgpr_write_b32 a32, v28
    v_accvgpr_write_b32 a33, v29
    v_accvgpr_write_b32 a34, v30
    v_accvgpr_write_b32 a35, v31
    v_accvgpr_read_b32 v28, a36
    v_accvgpr_read_b32 v29, a37
    v_accvgpr_read_b32 v30, a38
    v_accvgpr_read_b32 v31, a39
    v_mul_f32 v28, v28, v24
    v_mul_f32 v29, v29, v24
    v_mul_f32 v30, v30, v24
    v_mul_f32 v31, v31, v24
    v_accvgpr_write_b32 a36, v28
    v_accvgpr_write_b32 a37, v29
    v_accvgpr_write_b32 a38, v30
    v_accvgpr_write_b32 a39, v31
    v_accvgpr_read_b32 v28, a40
    v_accvgpr_read_b32 v29, a41
    v_accvgpr_read_b32 v30, a42
    v_accvgpr_read_b32 v31, a43
    v_mul_f32 v28, v28, v24
    v_mul_f32 v29, v29, v24
    v_mul_f32 v30, v30, v24
    v_mul_f32 v31, v31, v24
    v_accvgpr_write_b32 a40, v28
    v_accvgpr_write_b32 a41, v29
    v_accvgpr_write_b32 a42, v30
    v_accvgpr_write_b32 a43, v31
    v_accvgpr_read_b32 v28, a44
    v_accvgpr_read_b32 v29, a45
    v_accvgpr_read_b32 v30, a46
    v_accvgpr_read_b32 v31, a47
    v_mul_f32 v28, v28, v24
    v_mul_f32 v29, v29, v24
    v_mul_f32 v30, v30, v24
    v_mul_f32 v31, v31, v24
    v_accvgpr_write_b32 a44, v28
    v_accvgpr_write_b32 a45, v29
    v_accvgpr_write_b32 a46, v30
    v_accvgpr_write_b32 a47, v31
    v_accvgpr_read_b32 v28, a48
    v_accvgpr_read_b32 v29, a49
    v_accvgpr_read_b32 v30, a50
    v_accvgpr_read_b32 v31, a51
    v_mul_f32 v28, v28, v24
    v_mul_f32 v29, v29, v24
    v_mul_f32 v30, v30, v24
    v_mul_f32 v31, v31, v24
    v_accvgpr_write_b32 a48, v28
    v_accvgpr_write_b32 a49, v29
    v_accvgpr_write_b32 a50, v30
    v_accvgpr_write_b32 a51, v31
    v_accvgpr_read_b32 v28, a52
    v_accvgpr_read_b32 v29, a53
    v_accvgpr_read_b32 v30, a54
    v_accvgpr_read_b32 v31, a55
    v_mul_f32 v28, v28, v24
    v_mul_f32 v29, v29, v24
    v_mul_f32 v30, v30, v24
    v_mul_f32 v31, v31, v24
    v_accvgpr_write_b32 a52, v28
    v_accvgpr_write_b32 a53, v29
    v_accvgpr_write_b32 a54, v30
    v_accvgpr_write_b32 a55, v31
    v_accvgpr_read_b32 v28, a56
    v_accvgpr_read_b32 v29, a57
    v_accvgpr_read_b32 v30, a58
    v_accvgpr_read_b32 v31, a59
    v_mul_f32 v28, v28, v24
    v_mul_f32 v29, v29, v24
    v_mul_f32 v30, v30, v24
    v_mul_f32 v31, v31, v24
    v_accvgpr_write_b32 a56, v28
    v_accvgpr_write_b32 a57, v29
    v_accvgpr_write_b32 a58, v30
    v_accvgpr_write_b32 a59, v31
    v_accvgpr_read_b32 v28, a60
    v_accvgpr_read_b32 v29, a61
    v_accvgpr_read_b32 v30, a62
    v_accvgpr_read_b32 v31, a63
    v_mul_f32 v28, v28, v24
    v_mul_f32 v29, v29, v24
    v_mul_f32 v30, v30, v24
    v_mul_f32 v31, v31, v24
    v_accvgpr_write_b32 a60, v28
    v_accvgpr_write_b32 a61, v29
    v_accvgpr_write_b32 a62, v30
    v_accvgpr_write_b32 a63, v31
    v_accvgpr_read_b32 v28, a64
    v_accvgpr_read_b32 v29, a65
    v_accvgpr_read_b32 v30, a66
    v_accvgpr_read_b32 v31, a67
    v_mul_f32 v28, v28, v25
    v_mul_f32 v29, v29, v25
    v_mul_f32 v30, v30, v25
    v_mul_f32 v31, v31, v25
    v_accvgpr_write_b32 a64, v28
    v_accvgpr_write_b32 a65, v29
    v_accvgpr_write_b32 a66, v30
    v_accvgpr_write_b32 a67, v31
    v_accvgpr_read_b32 v28, a68
    v_accvgpr_read_b32 v29, a69
    v_accvgpr_read_b32 v30, a70
    v_accvgpr_read_b32 v31, a71
    v_mul_f32 v28, v28, v25
    v_mul_f32 v29, v29, v25
    v_mul_f32 v30, v30, v25
    v_mul_f32 v31, v31, v25
    v_accvgpr_write_b32 a68, v28
    v_accvgpr_write_b32 a69, v29
    v_accvgpr_write_b32 a70, v30
    v_accvgpr_write_b32 a71, v31
    v_accvgpr_read_b32 v28, a72
    v_accvgpr_read_b32 v29, a73
    v_accvgpr_read_b32 v30, a74
    v_accvgpr_read_b32 v31, a75
    v_mul_f32 v28, v28, v25
    v_mul_f32 v29, v29, v25
    v_mul_f32 v30, v30, v25
    v_mul_f32 v31, v31, v25
    v_accvgpr_write_b32 a72, v28
    v_accvgpr_write_b32 a73, v29
    v_accvgpr_write_b32 a74, v30
    v_accvgpr_write_b32 a75, v31
    v_accvgpr_read_b32 v28, a76
    v_accvgpr_read_b32 v29, a77
    v_accvgpr_read_b32 v30, a78
    v_accvgpr_read_b32 v31, a79
    v_mul_f32 v28, v28, v25
    v_mul_f32 v29, v29, v25
    v_mul_f32 v30, v30, v25
    v_mul_f32 v31, v31, v25
    v_accvgpr_write_b32 a76, v28
    v_accvgpr_write_b32 a77, v29
    v_accvgpr_write_b32 a78, v30
    v_accvgpr_write_b32 a79, v31
    v_accvgpr_read_b32 v28, a80
    v_accvgpr_read_b32 v29, a81
    v_accvgpr_read_b32 v30, a82
    v_accvgpr_read_b32 v31, a83
    v_mul_f32 v28, v28, v25
    v_mul_f32 v29, v29, v25
    v_mul_f32 v30, v30, v25
    v_mul_f32 v31, v31, v25
    v_accvgpr_write_b32 a80, v28
    v_accvgpr_write_b32 a81, v29
    v_accvgpr_write_b32 a82, v30
    v_accvgpr_write_b32 a83, v31
    v_accvgpr_read_b32 v28, a84
    v_accvgpr_read_b32 v29, a85
    v_accvgpr_read_b32 v30, a86
    v_accvgpr_read_b32 v31, a87
    v_mul_f32 v28, v28, v25
    v_mul_f32 v29, v29, v25
    v_mul_f32 v30, v30, v25
    v_mul_f32 v31, v31, v25
    v_accvgpr_write_b32 a84, v28
    v_accvgpr_write_b32 a85, v29
    v_accvgpr_write_b32 a86, v30
    v_accvgpr_write_b32 a87, v31
    v_accvgpr_read_b32 v28, a88
    v_accvgpr_read_b32 v29, a89
    v_accvgpr_read_b32 v30, a90
    v_accvgpr_read_b32 v31, a91
    v_mul_f32 v28, v28, v25
    v_mul_f32 v29, v29, v25
    v_mul_f32 v30, v30, v25
    v_mul_f32 v31, v31, v25
    v_accvgpr_write_b32 a88, v28
    v_accvgpr_write_b32 a89, v29
    v_accvgpr_write_b32 a90, v30
    v_accvgpr_write_b32 a91, v31
    v_accvgpr_read_b32 v28, a92
    v_accvgpr_read_b32 v29, a93
    v_accvgpr_read_b32 v30, a94
    v_accvgpr_read_b32 v31, a95
    v_mul_f32 v28, v28, v25
    v_mul_f32 v29, v29, v25
    v_mul_f32 v30, v30, v25
    v_mul_f32 v31, v31, v25
    v_accvgpr_write_b32 a92, v28
    v_accvgpr_write_b32 a93, v29
    v_accvgpr_write_b32 a94, v30
    v_accvgpr_write_b32 a95, v31
    v_accvgpr_read_b32 v28, a96
    v_accvgpr_read_b32 v29, a97
    v_accvgpr_read_b32 v30, a98
    v_accvgpr_read_b32 v31, a99
    v_mul_f32 v28, v28, v25
    v_mul_f32 v29, v29, v25
    v_mul_f32 v30, v30, v25
    v_mul_f32 v31, v31, v25
    v_accvgpr_write_b32 a96, v28
    v_accvgpr_write_b32 a97, v29
    v_accvgpr_write_b32 a98, v30
    v_accvgpr_write_b32 a99, v31
    v_accvgpr_read_b32 v28, a100
    v_accvgpr_read_b32 v29, a101
    v_accvgpr_read_b32 v30, a102
    v_accvgpr_read_b32 v31, a103
    v_mul_f32 v28, v28, v25
    v_mul_f32 v29, v29, v25
    v_mul_f32 v30, v30, v25
    v_mul_f32 v31, v31, v25
    v_accvgpr_write_b32 a100, v28
    v_accvgpr_write_b32 a101, v29
    v_accvgpr_write_b32 a102, v30
    v_accvgpr_write_b32 a103, v31
    v_accvgpr_read_b32 v28, a104
    v_accvgpr_read_b32 v29, a105
    v_accvgpr_read_b32 v30, a106
    v_accvgpr_read_b32 v31, a107
    v_mul_f32 v28, v28, v25
    v_mul_f32 v29, v29, v25
    v_mul_f32 v30, v30, v25
    v_mul_f32 v31, v31, v25
    v_accvgpr_write_b32 a104, v28
    v_accvgpr_write_b32 a105, v29
    v_accvgpr_write_b32 a106, v30
    v_accvgpr_write_b32 a107, v31
    v_accvgpr_read_b32 v28, a108
    v_accvgpr_read_b32 v29, a109
    v_accvgpr_read_b32 v30, a110
    v_accvgpr_read_b32 v31, a111
    v_mul_f32 v28, v28, v25
    v_mul_f32 v29, v29, v25
    v_mul_f32 v30, v30, v25
    v_mul_f32 v31, v31, v25
    v_accvgpr_write_b32 a108, v28
    v_accvgpr_write_b32 a109, v29
    v_accvgpr_write_b32 a110, v30
    v_accvgpr_write_b32 a111, v31
    v_accvgpr_read_b32 v28, a112
    v_accvgpr_read_b32 v29, a113
    v_accvgpr_read_b32 v30, a114
    v_accvgpr_read_b32 v31, a115
    v_mul_f32 v28, v28, v25
    v_mul_f32 v29, v29, v25
    v_mul_f32 v30, v30, v25
    v_mul_f32 v31, v31, v25
    v_accvgpr_write_b32 a112, v28
    v_accvgpr_write_b32 a113, v29
    v_accvgpr_write_b32 a114, v30
    v_accvgpr_write_b32 a115, v31
    v_accvgpr_read_b32 v28, a116
    v_accvgpr_read_b32 v29, a117
    v_accvgpr_read_b32 v30, a118
    v_accvgpr_read_b32 v31, a119
    v_mul_f32 v28, v28, v25
    v_mul_f32 v29, v29, v25
    v_mul_f32 v30, v30, v25
    v_mul_f32 v31, v31, v25
    v_accvgpr_write_b32 a116, v28
    v_accvgpr_write_b32 a117, v29
    v_accvgpr_write_b32 a118, v30
    v_accvgpr_write_b32 a119, v31
    v_accvgpr_read_b32 v28, a120
    v_accvgpr_read_b32 v29, a121
    v_accvgpr_read_b32 v30, a122
    v_accvgpr_read_b32 v31, a123
    v_mul_f32 v28, v28, v25
    v_mul_f32 v29, v29, v25
    v_mul_f32 v30, v30, v25
    v_mul_f32 v31, v31, v25
    v_accvgpr_write_b32 a120, v28
    v_accvgpr_write_b32 a121, v29
    v_accvgpr_write_b32 a122, v30
    v_accvgpr_write_b32 a123, v31
    v_accvgpr_read_b32 v28, a124
    v_accvgpr_read_b32 v29, a125
    v_accvgpr_read_b32 v30, a126
    v_accvgpr_read_b32 v31, a127
    v_mul_f32 v28, v28, v25
    v_mul_f32 v29, v29, v25
    v_mul_f32 v30, v30, v25
    v_mul_f32 v31, v31, v25
    v_accvgpr_write_b32 a124, v28
    v_accvgpr_write_b32 a125, v29
    v_accvgpr_write_b32 a126, v30
    v_accvgpr_write_b32 a127, v31
    v_accvgpr_read_b32 v28, a128
    v_accvgpr_read_b32 v29, a129
    v_accvgpr_read_b32 v30, a130
    v_accvgpr_read_b32 v31, a131
    v_mul_f32 v28, v28, v26
    v_mul_f32 v29, v29, v26
    v_mul_f32 v30, v30, v26
    v_mul_f32 v31, v31, v26
    v_accvgpr_write_b32 a128, v28
    v_accvgpr_write_b32 a129, v29
    v_accvgpr_write_b32 a130, v30
    v_accvgpr_write_b32 a131, v31
    v_accvgpr_read_b32 v28, a132
    v_accvgpr_read_b32 v29, a133
    v_accvgpr_read_b32 v30, a134
    v_accvgpr_read_b32 v31, a135
    v_mul_f32 v28, v28, v26
    v_mul_f32 v29, v29, v26
    v_mul_f32 v30, v30, v26
    v_mul_f32 v31, v31, v26
    v_accvgpr_write_b32 a132, v28
    v_accvgpr_write_b32 a133, v29
    v_accvgpr_write_b32 a134, v30
    v_accvgpr_write_b32 a135, v31
    v_accvgpr_read_b32 v28, a136
    v_accvgpr_read_b32 v29, a137
    v_accvgpr_read_b32 v30, a138
    v_accvgpr_read_b32 v31, a139
    v_mul_f32 v28, v28, v26
    v_mul_f32 v29, v29, v26
    v_mul_f32 v30, v30, v26
    v_mul_f32 v31, v31, v26
    v_accvgpr_write_b32 a136, v28
    v_accvgpr_write_b32 a137, v29
    v_accvgpr_write_b32 a138, v30
    v_accvgpr_write_b32 a139, v31
    v_accvgpr_read_b32 v28, a140
    v_accvgpr_read_b32 v29, a141
    v_accvgpr_read_b32 v30, a142
    v_accvgpr_read_b32 v31, a143
    v_mul_f32 v28, v28, v26
    v_mul_f32 v29, v29, v26
    v_mul_f32 v30, v30, v26
    v_mul_f32 v31, v31, v26
    v_accvgpr_write_b32 a140, v28
    v_accvgpr_write_b32 a141, v29
    v_accvgpr_write_b32 a142, v30
    v_accvgpr_write_b32 a143, v31
    v_accvgpr_read_b32 v28, a144
    v_accvgpr_read_b32 v29, a145
    v_accvgpr_read_b32 v30, a146
    v_accvgpr_read_b32 v31, a147
    v_mul_f32 v28, v28, v26
    v_mul_f32 v29, v29, v26
    v_mul_f32 v30, v30, v26
    v_mul_f32 v31, v31, v26
    v_accvgpr_write_b32 a144, v28
    v_accvgpr_write_b32 a145, v29
    v_accvgpr_write_b32 a146, v30
    v_accvgpr_write_b32 a147, v31
    v_accvgpr_read_b32 v28, a148
    v_accvgpr_read_b32 v29, a149
    v_accvgpr_read_b32 v30, a150
    v_accvgpr_read_b32 v31, a151
    v_mul_f32 v28, v28, v26
    v_mul_f32 v29, v29, v26
    v_mul_f32 v30, v30, v26
    v_mul_f32 v31, v31, v26
    v_accvgpr_write_b32 a148, v28
    v_accvgpr_write_b32 a149, v29
    v_accvgpr_write_b32 a150, v30
    v_accvgpr_write_b32 a151, v31
    v_accvgpr_read_b32 v28, a152
    v_accvgpr_read_b32 v29, a153
    v_accvgpr_read_b32 v30, a154
    v_accvgpr_read_b32 v31, a155
    v_mul_f32 v28, v28, v26
    v_mul_f32 v29, v29, v26
    v_mul_f32 v30, v30, v26
    v_mul_f32 v31, v31, v26
    v_accvgpr_write_b32 a152, v28
    v_accvgpr_write_b32 a153, v29
    v_accvgpr_write_b32 a154, v30
    v_accvgpr_write_b32 a155, v31
    v_accvgpr_read_b32 v28, a156
    v_accvgpr_read_b32 v29, a157
    v_accvgpr_read_b32 v30, a158
    v_accvgpr_read_b32 v31, a159
    v_mul_f32 v28, v28, v26
    v_mul_f32 v29, v29, v26
    v_mul_f32 v30, v30, v26
    v_mul_f32 v31, v31, v26
    v_accvgpr_write_b32 a156, v28
    v_accvgpr_write_b32 a157, v29
    v_accvgpr_write_b32 a158, v30
    v_accvgpr_write_b32 a159, v31
    v_accvgpr_read_b32 v28, a160
    v_accvgpr_read_b32 v29, a161
    v_accvgpr_read_b32 v30, a162
    v_accvgpr_read_b32 v31, a163
    v_mul_f32 v28, v28, v26
    v_mul_f32 v29, v29, v26
    v_mul_f32 v30, v30, v26
    v_mul_f32 v31, v31, v26
    v_accvgpr_write_b32 a160, v28
    v_accvgpr_write_b32 a161, v29
    v_accvgpr_write_b32 a162, v30
    v_accvgpr_write_b32 a163, v31
    v_accvgpr_read_b32 v28, a164
    v_accvgpr_read_b32 v29, a165
    v_accvgpr_read_b32 v30, a166
    v_accvgpr_read_b32 v31, a167
    v_mul_f32 v28, v28, v26
    v_mul_f32 v29, v29, v26
    v_mul_f32 v30, v30, v26
    v_mul_f32 v31, v31, v26
    v_accvgpr_write_b32 a164, v28
    v_accvgpr_write_b32 a165, v29
    v_accvgpr_write_b32 a166, v30
    v_accvgpr_write_b32 a167, v31
    v_accvgpr_read_b32 v28, a168
    v_accvgpr_read_b32 v29, a169
    v_accvgpr_read_b32 v30, a170
    v_accvgpr_read_b32 v31, a171
    v_mul_f32 v28, v28, v26
    v_mul_f32 v29, v29, v26
    v_mul_f32 v30, v30, v26
    v_mul_f32 v31, v31, v26
    v_accvgpr_write_b32 a168, v28
    v_accvgpr_write_b32 a169, v29
    v_accvgpr_write_b32 a170, v30
    v_accvgpr_write_b32 a171, v31
    v_accvgpr_read_b32 v28, a172
    v_accvgpr_read_b32 v29, a173
    v_accvgpr_read_b32 v30, a174
    v_accvgpr_read_b32 v31, a175
    v_mul_f32 v28, v28, v26
    v_mul_f32 v29, v29, v26
    v_mul_f32 v30, v30, v26
    v_mul_f32 v31, v31, v26
    v_accvgpr_write_b32 a172, v28
    v_accvgpr_write_b32 a173, v29
    v_accvgpr_write_b32 a174, v30
    v_accvgpr_write_b32 a175, v31
    v_accvgpr_read_b32 v28, a176
    v_accvgpr_read_b32 v29, a177
    v_accvgpr_read_b32 v30, a178
    v_accvgpr_read_b32 v31, a179
    v_mul_f32 v28, v28, v26
    v_mul_f32 v29, v29, v26
    v_mul_f32 v30, v30, v26
    v_mul_f32 v31, v31, v26
    v_accvgpr_write_b32 a176, v28
    v_accvgpr_write_b32 a177, v29
    v_accvgpr_write_b32 a178, v30
    v_accvgpr_write_b32 a179, v31
    v_accvgpr_read_b32 v28, a180
    v_accvgpr_read_b32 v29, a181
    v_accvgpr_read_b32 v30, a182
    v_accvgpr_read_b32 v31, a183
    v_mul_f32 v28, v28, v26
    v_mul_f32 v29, v29, v26
    v_mul_f32 v30, v30, v26
    v_mul_f32 v31, v31, v26
    v_accvgpr_write_b32 a180, v28
    v_accvgpr_write_b32 a181, v29
    v_accvgpr_write_b32 a182, v30
    v_accvgpr_write_b32 a183, v31
    v_accvgpr_read_b32 v28, a184
    v_accvgpr_read_b32 v29, a185
    v_accvgpr_read_b32 v30, a186
    v_accvgpr_read_b32 v31, a187
    v_mul_f32 v28, v28, v26
    v_mul_f32 v29, v29, v26
    v_mul_f32 v30, v30, v26
    v_mul_f32 v31, v31, v26
    v_accvgpr_write_b32 a184, v28
    v_accvgpr_write_b32 a185, v29
    v_accvgpr_write_b32 a186, v30
    v_accvgpr_write_b32 a187, v31
    v_accvgpr_read_b32 v28, a188
    v_accvgpr_read_b32 v29, a189
    v_accvgpr_read_b32 v30, a190
    v_accvgpr_read_b32 v31, a191
    v_mul_f32 v28, v28, v26
    v_mul_f32 v29, v29, v26
    v_mul_f32 v30, v30, v26
    v_mul_f32 v31, v31, v26
    v_accvgpr_write_b32 a188, v28
    v_accvgpr_write_b32 a189, v29
    v_accvgpr_write_b32 a190, v30
    v_accvgpr_write_b32 a191, v31
    v_accvgpr_read_b32 v28, a192
    v_accvgpr_read_b32 v29, a193
    v_accvgpr_read_b32 v30, a194
    v_accvgpr_read_b32 v31, a195
    v_mul_f32 v28, v28, v27
    v_mul_f32 v29, v29, v27
    v_mul_f32 v30, v30, v27
    v_mul_f32 v31, v31, v27
    v_accvgpr_write_b32 a192, v28
    v_accvgpr_write_b32 a193, v29
    v_accvgpr_write_b32 a194, v30
    v_accvgpr_write_b32 a195, v31
    v_accvgpr_read_b32 v28, a196
    v_accvgpr_read_b32 v29, a197
    v_accvgpr_read_b32 v30, a198
    v_accvgpr_read_b32 v31, a199
    v_mul_f32 v28, v28, v27
    v_mul_f32 v29, v29, v27
    v_mul_f32 v30, v30, v27
    v_mul_f32 v31, v31, v27
    v_accvgpr_write_b32 a196, v28
    v_accvgpr_write_b32 a197, v29
    v_accvgpr_write_b32 a198, v30
    v_accvgpr_write_b32 a199, v31
    v_accvgpr_read_b32 v28, a200
    v_accvgpr_read_b32 v29, a201
    v_accvgpr_read_b32 v30, a202
    v_accvgpr_read_b32 v31, a203
    v_mul_f32 v28, v28, v27
    v_mul_f32 v29, v29, v27
    v_mul_f32 v30, v30, v27
    v_mul_f32 v31, v31, v27
    v_accvgpr_write_b32 a200, v28
    v_accvgpr_write_b32 a201, v29
    v_accvgpr_write_b32 a202, v30
    v_accvgpr_write_b32 a203, v31
    v_accvgpr_read_b32 v28, a204
    v_accvgpr_read_b32 v29, a205
    v_accvgpr_read_b32 v30, a206
    v_accvgpr_read_b32 v31, a207
    v_mul_f32 v28, v28, v27
    v_mul_f32 v29, v29, v27
    v_mul_f32 v30, v30, v27
    v_mul_f32 v31, v31, v27
    v_accvgpr_write_b32 a204, v28
    v_accvgpr_write_b32 a205, v29
    v_accvgpr_write_b32 a206, v30
    v_accvgpr_write_b32 a207, v31
    v_accvgpr_read_b32 v28, a208
    v_accvgpr_read_b32 v29, a209
    v_accvgpr_read_b32 v30, a210
    v_accvgpr_read_b32 v31, a211
    v_mul_f32 v28, v28, v27
    v_mul_f32 v29, v29, v27
    v_mul_f32 v30, v30, v27
    v_mul_f32 v31, v31, v27
    v_accvgpr_write_b32 a208, v28
    v_accvgpr_write_b32 a209, v29
    v_accvgpr_write_b32 a210, v30
    v_accvgpr_write_b32 a211, v31
    v_accvgpr_read_b32 v28, a212
    v_accvgpr_read_b32 v29, a213
    v_accvgpr_read_b32 v30, a214
    v_accvgpr_read_b32 v31, a215
    v_mul_f32 v28, v28, v27
    v_mul_f32 v29, v29, v27
    v_mul_f32 v30, v30, v27
    v_mul_f32 v31, v31, v27
    v_accvgpr_write_b32 a212, v28
    v_accvgpr_write_b32 a213, v29
    v_accvgpr_write_b32 a214, v30
    v_accvgpr_write_b32 a215, v31
    v_accvgpr_read_b32 v28, a216
    v_accvgpr_read_b32 v29, a217
    v_accvgpr_read_b32 v30, a218
    v_accvgpr_read_b32 v31, a219
    v_mul_f32 v28, v28, v27
    v_mul_f32 v29, v29, v27
    v_mul_f32 v30, v30, v27
    v_mul_f32 v31, v31, v27
    v_accvgpr_write_b32 a216, v28
    v_accvgpr_write_b32 a217, v29
    v_accvgpr_write_b32 a218, v30
    v_accvgpr_write_b32 a219, v31
    v_accvgpr_read_b32 v28, a220
    v_accvgpr_read_b32 v29, a221
    v_accvgpr_read_b32 v30, a222
    v_accvgpr_read_b32 v31, a223
    v_mul_f32 v28, v28, v27
    v_mul_f32 v29, v29, v27
    v_mul_f32 v30, v30, v27
    v_mul_f32 v31, v31, v27
    v_accvgpr_write_b32 a220, v28
    v_accvgpr_write_b32 a221, v29
    v_accvgpr_write_b32 a222, v30
    v_accvgpr_write_b32 a223, v31
    v_accvgpr_read_b32 v28, a224
    v_accvgpr_read_b32 v29, a225
    v_accvgpr_read_b32 v30, a226
    v_accvgpr_read_b32 v31, a227
    v_mul_f32 v28, v28, v27
    v_mul_f32 v29, v29, v27
    v_mul_f32 v30, v30, v27
    v_mul_f32 v31, v31, v27
    v_accvgpr_write_b32 a224, v28
    v_accvgpr_write_b32 a225, v29
    v_accvgpr_write_b32 a226, v30
    v_accvgpr_write_b32 a227, v31
    v_accvgpr_read_b32 v28, a228
    v_accvgpr_read_b32 v29, a229
    v_accvgpr_read_b32 v30, a230
    v_accvgpr_read_b32 v31, a231
    v_mul_f32 v28, v28, v27
    v_mul_f32 v29, v29, v27
    v_mul_f32 v30, v30, v27
    v_mul_f32 v31, v31, v27
    v_accvgpr_write_b32 a228, v28
    v_accvgpr_write_b32 a229, v29
    v_accvgpr_write_b32 a230, v30
    v_accvgpr_write_b32 a231, v31
    v_accvgpr_read_b32 v28, a232
    v_accvgpr_read_b32 v29, a233
    v_accvgpr_read_b32 v30, a234
    v_accvgpr_read_b32 v31, a235
    v_mul_f32 v28, v28, v27
    v_mul_f32 v29, v29, v27
    v_mul_f32 v30, v30, v27
    v_mul_f32 v31, v31, v27
    v_accvgpr_write_b32 a232, v28
    v_accvgpr_write_b32 a233, v29
    v_accvgpr_write_b32 a234, v30
    v_accvgpr_write_b32 a235, v31
    v_accvgpr_read_b32 v28, a236
    v_accvgpr_read_b32 v29, a237
    v_accvgpr_read_b32 v30, a238
    v_accvgpr_read_b32 v31, a239
    v_mul_f32 v28, v28, v27
    v_mul_f32 v29, v29, v27
    v_mul_f32 v30, v30, v27
    v_mul_f32 v31, v31, v27
    v_accvgpr_write_b32 a236, v28
    v_accvgpr_write_b32 a237, v29
    v_accvgpr_write_b32 a238, v30
    v_accvgpr_write_b32 a239, v31
    v_accvgpr_read_b32 v28, a240
    v_accvgpr_read_b32 v29, a241
    v_accvgpr_read_b32 v30, a242
    v_accvgpr_read_b32 v31, a243
    v_mul_f32 v28, v28, v27
    v_mul_f32 v29, v29, v27
    v_mul_f32 v30, v30, v27
    v_mul_f32 v31, v31, v27
    v_accvgpr_write_b32 a240, v28
    v_accvgpr_write_b32 a241, v29
    v_accvgpr_write_b32 a242, v30
    v_accvgpr_write_b32 a243, v31
    v_accvgpr_read_b32 v28, a244
    v_accvgpr_read_b32 v29, a245
    v_accvgpr_read_b32 v30, a246
    v_accvgpr_read_b32 v31, a247
    v_mul_f32 v28, v28, v27
    v_mul_f32 v29, v29, v27
    v_mul_f32 v30, v30, v27
    v_mul_f32 v31, v31, v27
    v_accvgpr_write_b32 a244, v28
    v_accvgpr_write_b32 a245, v29
    v_accvgpr_write_b32 a246, v30
    v_accvgpr_write_b32 a247, v31
    v_accvgpr_read_b32 v28, a248
    v_accvgpr_read_b32 v29, a249
    v_accvgpr_read_b32 v30, a250
    v_accvgpr_read_b32 v31, a251
    v_mul_f32 v28, v28, v27
    v_mul_f32 v29, v29, v27
    v_mul_f32 v30, v30, v27
    v_mul_f32 v31, v31, v27
    v_accvgpr_write_b32 a248, v28
    v_accvgpr_write_b32 a249, v29
    v_accvgpr_write_b32 a250, v30
    v_accvgpr_write_b32 a251, v31
    v_accvgpr_read_b32 v28, a252
    v_accvgpr_read_b32 v29, a253
    v_accvgpr_read_b32 v30, a254
    v_accvgpr_read_b32 v31, a255
    v_mul_f32 v28, v28, v27
    v_mul_f32 v29, v29, v27
    v_mul_f32 v30, v30, v27
    v_mul_f32 v31, v31, v27
    v_accvgpr_write_b32 a252, v28
    v_accvgpr_write_b32 a253, v29
    v_accvgpr_write_b32 a254, v30
    v_accvgpr_write_b32 a255, v31
    v_mov_b32 v24, 0xff800000
    v_mov_b32 v25, 0xff800000
    v_mov_b32 v26, 0xff800000
    v_mov_b32 v27, 0xff800000
    s_mov_b32 s33, 0
    s_nop 1
    s_setpc_b64 s[34:35]
L_skipA_0_stub:
    s_getpc_b64 s[34:35]
Lpc_L_skipA_0:
    s_sub_u32 s34, s34, Lpc_L_skipA_0 - L_skipA_0
    s_subb_u32 s35, s35, 0
    s_branch L_rare1
L_skipB_0_stub:
    s_getpc_b64 s[34:35]
Lpc_L_skipB_0:
    s_sub_u32 s34, s34, Lpc_L_skipB_0 - L_skipB_0
    s_subb_u32 s35, s35, 0
    s_branch L_rare2
L_skipA_1_stub:
    s_getpc_b64 s[34:35]
Lpc_L_skipA_1:
    s_sub_u32 s34, s34, Lpc_L_skipA_1 - L_skipA_1
    s_subb_u32 s35, s35, 0
    s_branch L_rare1
L_skipB_1_stub:
    s_getpc_b64 s[34:35]
Lpc_L_skipB_1:
    s_sub_u32 s34, s34, Lpc_L_skipB_1 - L_skipB_1
    s_subb_u32 s35, s35, 0
    s_branch L_rare2
L_skipA_2_stub:
    s_getpc_b64 s[34:35]
Lpc_L_skipA_2:
    s_sub_u32 s34, s34, Lpc_L_skipA_2 - L_skipA_2
    s_subb_u32 s35, s35, 0
    s_branch L_rare1
L_skipB_2_stub:
    s_getpc_b64 s[34:35]
Lpc_L_skipB_2:
    s_sub_u32 s34, s34, Lpc_L_skipB_2 - L_skipB_2
    s_subb_u32 s35, s35, 0
    s_branch L_rare2
L_skipA_3_stub:
    s_getpc_b64 s[34:35]
Lpc_L_skipA_3:
    s_sub_u32 s34, s34, Lpc_L_skipA_3 - L_skipA_3
    s_subb_u32 s35, s35, 0
    s_branch L_rare1
L_skipB_3_stub:
    s_getpc_b64 s[34:35]
Lpc_L_skipB_3:
    s_sub_u32 s34, s34, Lpc_L_skipB_3 - L_skipB_3
    s_subb_u32 s35, s35, 0
    s_branch L_rare2
L_skipA_28_stub:
    s_getpc_b64 s[34:35]
Lpc_L_skipA_28:
    s_sub_u32 s34, s34, Lpc_L_skipA_28 - L_skipA_28
    s_subb_u32 s35, s35, 0
    s_branch L_rare1
L_skipB_28_stub:
    s_getpc_b64 s[34:35]
Lpc_L_skipB_28:
    s_sub_u32 s34, s34, Lpc_L_skipB_28 - L_skipB_28
    s_subb_u32 s35, s35, 0
    s_branch L_rare2
L_skipA_29_stub:
    s_getpc_b64 s[34:35]
Lpc_L_skipA_29:
    s_sub_u32 s34, s34, Lpc_L_skipA_29 - L_skipA_29
    s_subb_u32 s35, s35, 0
    s_branch L_rare1
L_skipB_29_stub:
    s_getpc_b64 s[34:35]
Lpc_L_skipB_29:
    s_sub_u32 s34, s34, Lpc_L_skipB_29 - L_skipB_29
    s_subb_u32 s35, s35, 0
    s_branch L_rare2
L_skipA_30_stub:
    s_getpc_b64 s[34:35]
Lpc_L_skipA_30:
    s_sub_u32 s34, s34, Lpc_L_skipA_30 - L_skipA_30
    s_subb_u32 s35, s35, 0
    s_branch L_rare1
L_skipB_30_stub:
    s_getpc_b64 s[34:35]
Lpc_L_skipB_30:
    s_sub_u32 s34, s34, Lpc_L_skipB_30 - L_skipB_30
    s_subb_u32 s35, s35, 0
    s_branch L_rare2
.section .rodata,"a"
.p2align 6
.amdhsa_kernel standalone__mha_softmax__near_ridge_kernel
  .amdhsa_next_free_vgpr 512
  .amdhsa_next_free_sgpr 64
  .amdhsa_accum_offset 256
  .amdhsa_group_segment_fixed_size 0
  .amdhsa_kernarg_size 48
  .amdhsa_user_sgpr_count 2
  .amdhsa_user_sgpr_kernarg_segment_ptr 1
  .amdhsa_system_sgpr_workgroup_id_x 1
.end_amdhsa_kernel
```
